```python
import torch

def _softmax(x, axis=-1):
    return torch.softmax(x, dim=axis)
def _gelu(x):
    return torch.nn.functional.gelu(x, approximate="tanh")
def _silu(x):
    return torch.nn.functional.silu(x)
def _sigmoid(x):
    return torch.sigmoid(x)
def _layernorm(x, axis=-1, eps=1e-5):
    m = x.mean(dim=axis, keepdim=True)
    v = x.var(dim=axis, keepdim=True, unbiased=False)
    return (x - m) / torch.sqrt(v + eps)
def _scatter_add(tgt, idx, src, axis=0):
    return tgt.clone().index_add_(axis, idx, src)
def _segment_sum(src, seg, n):
    out = torch.zeros((n,) + src.shape[1:], dtype=src.dtype)
    return out.index_add_(0, seg, src)
def _pad(x, pw):
    flat = tuple(v for pair in reversed(pw) for v in pair)
    return torch.nn.functional.pad(x, flat)

kernel_name = 'concat_heads__ssm_conv_s4__linear_kernel_hedgehog__prompt'

def setup_inputs():

    _w = (lambda a: (lambda t: t.to(torch.bfloat16) if t.is_floating_point() else t)(torch.as_tensor(a)))
    def _A_setup():
        B, L, D, N = 1, 2048, 640, 128
        A_re = -(lambda _x: torch.exp(torch.as_tensor(_x)))((lambda *s: torch.randn(*s, dtype=torch.bfloat16) * 3.2)(D, N))
        A_im = torch.pi * (lambda *s: torch.randn(*s, dtype=torch.bfloat16) * 0.2)(D, N)
        B_re = (lambda *s: torch.randn(*s, dtype=torch.bfloat16) * 0.4)(D, N)
        B_im = (lambda *s: torch.randn(*s, dtype=torch.bfloat16) * 0.4)(D, N)
        C_re = (lambda *s: torch.randn(*s, dtype=torch.bfloat16) * 0.4)(D, N)
        C_im = (lambda *s: torch.randn(*s, dtype=torch.bfloat16) * 0.4)(D, N)
        log_dt = (lambda *s: torch.randn(*s, dtype=torch.bfloat16) * 0.2)(D) * 0.5 - 4.0
        Dskip = (lambda *s: torch.randn(*s, dtype=torch.bfloat16) * 0.4)(D)
        return {
            "u": _w((lambda *s: torch.randn(*s, dtype=torch.bfloat16) * 0.05)(B, L, D)),
            "A_re": _w(A_re),
            "A_im": _w(A_im),
            "B_re": _w(B_re),
            "B_im": _w(B_im),
            "C_re": _w(C_re),
            "C_im": _w(C_im),
            "log_dt": _w(log_dt),
            "Dskip": _w(Dskip),
        }
    _A_in = _A_setup()

    def _B_setup():
        B, S, D, H = 1, 2048, 640, 32
        Dh = D // H
        return {
            "x": _w((lambda *s: torch.randn(*s, dtype=torch.bfloat16) * 0.4)(B, S, D)),
            "wqkv": _w((lambda *s: torch.randn(*s, dtype=torch.bfloat16) * 0.4)(D, 3 * D)),
            "w_phi": _w((lambda *s: torch.randn(*s, dtype=torch.bfloat16) * 0.4)(H, Dh, Dh) * (Dh ** -0.5)),
            "wo": _w((lambda *s: torch.randn(*s, dtype=torch.bfloat16) * 0.05)(D, D)),
        }
    _B_in = _B_setup()

    return {
        "A_u": _A_in["u"],
        "A_A_re": _A_in["A_re"],
        "A_A_im": _A_in["A_im"],
        "A_B_re": _A_in["B_re"],
        "A_B_im": _A_in["B_im"],
        "A_C_re": _A_in["C_re"],
        "A_C_im": _A_in["C_im"],
        "A_log_dt": _A_in["log_dt"],
        "A_Dskip": _A_in["Dskip"],
        "B_x": _B_in["x"],
        "B_wqkv": _B_in["wqkv"],
        "B_w_phi": _B_in["w_phi"],
        "B_wo": _B_in["wo"],
    }

def reference(A_u, A_A_re, A_A_im, A_B_re, A_B_im, A_C_re, A_C_im, A_log_dt, A_Dskip, B_x, B_wqkv, B_w_phi, B_wo):
    def _A_ref(u, A_re, A_im, B_re, B_im, C_re, C_im, log_dt, Dskip):
        Bsz, L, D = u.shape
        dt = torch.exp(log_dt)[:, None]
        A = A_re + 1j * A_im
        Bc = B_re + 1j * B_im
        Cc = C_re + 1j * C_im
        logdA = dt * A
        dB = dt * Bc
        l = (lambda x, dt: x.to(dt))(torch.arange(L), A_re.dtype)
        P = torch.exp(logdA[:, :, None] * l[None, None, :])
        K = torch.einsum("dn,dnl,dn->dl", Cc, P, dB).real
        L2 = 2 * L
        Kp = _pad(K, ((0, 0), (0, L)))
        up = (lambda x, *d: x.permute(*d))(u, 0, 2, 1)
        up = _pad(up, ((0, 0), (0, 0), (0, L)))
        Kf = (lambda x, axes=(-2,-1): torch.fft.rfft2(x.float(), dim=axes))(Kp[:, None, :], axes=(-2, -1))
        Uf = (lambda x, axes=(-2,-1): torch.fft.rfft2(x.float(), dim=axes))(up[:, :, None, :], axes=(-2, -1))
        Yf = Uf * Kf[None, :, :, :]
        y = (lambda x, s, axes=(-2,-1): torch.fft.irfft2(x, s=s, dim=axes).to(torch.bfloat16))(Yf, (1, L2), axes=(-2, -1))[:, :, 0, :L]
        y = (lambda x, *d: x.permute(*d))(y, 0, 2, 1) + u * Dskip[None, None, :]
        return y

    def _B_ref(x, wqkv, w_phi, wo):
        B, S, D = x.shape
        H = 32; Dh = D // H
        qkv = (lambda x, *d: x.permute(*d))((x @ wqkv).reshape(B, S, 3, H, Dh), 2, 0, 3, 1, 4)
        q, k, v = qkv[0], qkv[1], qkv[2]
        pq = torch.einsum("bhsd,hdf->bhsf", q, w_phi)
        pk = torch.einsum("bhsd,hdf->bhsf", k, w_phi)
        phi_q = torch.concatenate([_softmax(pq, axis=-1), _softmax(-pq, axis=-1)], axis=-1)
        phi_k = torch.concatenate([_softmax(pk, axis=-1), _softmax(-pk, axis=-1)], axis=-1)
        kv = torch.einsum("bhsf,bhsd->bhfd", phi_k, v)
        z  = torch.einsum("bhsf->bhf", phi_k)
        num = torch.einsum("bhqf,bhfd->bhqd", phi_q, kv)
        den = torch.einsum("bhqf,bhf->bhq", phi_q, z)[..., None] + 1e-6
        o = num / den
        return (lambda x, *d: x.permute(*d))(o, 0, 2, 1, 3).reshape(B, S, D) @ wo

    a = _A_ref(A_u, A_A_re, A_A_im, A_B_re, A_B_im, A_C_re, A_C_im, A_log_dt, A_Dskip)
    b = _B_ref(B_x, B_wqkv, B_w_phi, B_wo)
    return torch.concatenate([a, b], axis=-1)
```

```asm
; @launch grid=(512,1,1) block=(256,1,1) lds=81920
.amdgcn_target "amdgcn-amd-amdhsa--gfx950"
.text
.globl concat_heads__ssm_conv_s4__linear_kernel_hedgehog__prompt_kernel
.p2align 8
.type concat_heads__ssm_conv_s4__linear_kernel_hedgehog__prompt_kernel,@function
concat_heads__ssm_conv_s4__linear_kernel_hedgehog__prompt_kernel:
    s_cmp_ge_u32 s2, 512
    s_cbranch_scc1 L_end
    s_xor_b32 s2, s2, 256
    s_load_dwordx16 s[16:31], s[0:1], 0
    s_load_dwordx16 s[32:47], s[0:1], 64
    s_getpc_b64 s[4:5]
L_pc:
    v_lshrrev_b32 v1, 6, v0
    v_and_b32 v2, 63, v0
    v_readfirstlane_b32 s3, v1
    s_and_b32 s5, s5, 0xffff
    s_mov_b32 s6, L_code_end-L_pc
    s_mov_b32 s7, 0x20000
    s_lshr_b32 s8, s2, 3
    s_and_b32 s8, s8, 15
    s_lshl_b32 s8, s8, 12
    v_lshlrev_b32 v3, 4, v0
    v_add_u32 v3, s8, v3
    buffer_load_dwordx4 v[252:255], v3, s[4:7], 0 offen
    s_waitcnt lgkmcnt(0)
    s_mov_b32 s48, s46
    s_and_b32 s49, s47, 0xffff
    s_mov_b32 s50, 33554432
    s_mov_b32 s51, 0x20000
    s_mov_b32 s52, s44
    s_and_b32 s53, s45, 0xffff
    s_mov_b32 s54, 256
    s_mov_b32 s55, 0x20000
    s_cmp_lt_u32 s2, 256
    s_cbranch_scc1 L_roleB
    s_sub_u32 s8, s2, 256
    s_and_b32 s9, s8, 7
    s_lshr_b32 s10, s8, 3
    s_cmp_ge_u32 s10, 20
    s_cbranch_scc1 L_notA
L_roleA:
    s_setprio 3
    s_mul_i32 s11, s9, 20
    s_add_u32 s11, s11, s10
    s_lshl_b32 s12, s11, 2
    s_add_u32 s12, s12, s3
    s_lshl_b32 s13, s12, 8
    v_lshl_add_u32 v3, v2, 2, s13
    s_lshl_b32 s13, s3, 9
    s_add_u32 s13, s13, s2
    s_cmp_lg_u32 s13, 256
    s_cbranch_scc1 L_a_nonon
    s_memrealtime s[14:15]
    v_mov_b32 v4, 0
    s_waitcnt lgkmcnt(0)
    s_or_b32 s14, s14, 1
    v_mov_b32 v5, s14
    s_mov_b64 exec, 1
    buffer_store_dword v5, v4, s[52:55], 0 offen sc1
    s_mov_b64 exec, -1
L_a_nonon:
    global_load_dword v8, v3, s[18:19]
    global_load_dword v9, v3, s[20:21]
    global_load_dword v10, v3, s[22:23]
    global_load_dword v11, v3, s[24:25]
    global_load_dword v12, v3, s[26:27]
    global_load_dword v13, v3, s[28:29]
    s_mov_b32 s56, s16
    s_and_b32 s57, s17, 0xffff
    s_mov_b32 s58, 2621440
    s_mov_b32 s59, 0x20000
    s_setprio 1
    s_lshl_b32 s13, s11, 3
    s_load_dwordx2 s[14:15], s[30:31], s13
    s_load_dwordx2 s[76:77], s[32:33], s13
    s_mov_b32 s64, s42
    s_and_b32 s65, s43, 0xffff
    s_mov_b32 s66, 5242880
    s_mov_b32 s67, 0x20000
    s_mul_i32 s70, s3, 20480
    v_mov_b32 v4, 0
    v_mov_b32 v5, 0
    v_lshl_add_u32 v6, v2, 3, s70
    s_waitcnt lgkmcnt(0)
    s_cmp_ge_u32 s3, 2
    s_cselect_b32 s14, s15, s14
    s_and_b32 s15, s3, 1
    s_lshl_b32 s15, s15, 4
    s_lshr_b32 s14, s14, s15
    s_lshl_b32 s14, s14, 16
    v_mov_b32 v14, s14
    s_mov_b32 s71, 1069066811
    s_mov_b32 s72, 849703008
    v_mul_f32 v15, s71, v14
    v_fma_f32 v16, v14, s71, -v15
    v_fma_f32 v16, v14, s72, v16
    v_exp_f32 v15, v15
    v_mul_f32 v16, 1060205080, v16
    v_fma_f32 v15, v15, v16, v15
    v_cvt_pk_bf16_f32 v15, v15, v15
    v_lshlrev_b32 v14, 16, v15
    s_waitcnt vmcnt(3)
    v_lshlrev_b32 v40, 16, v10
    s_waitcnt vmcnt(2)
    v_lshlrev_b32 v41, 16, v11
    s_waitcnt vmcnt(1)
    v_lshlrev_b32 v42, 16, v12
    s_waitcnt vmcnt(0)
    v_lshlrev_b32 v43, 16, v13
    v_pk_mul_f32 v[40:41], v[40:41], v[14:15] op_sel_hi:[1,0]
    v_pk_mul_f32 v[38:39], v[40:41], v[42:43] op_sel_hi:[1,0]
    v_pk_fma_f32 v[26:27], v[40:41], v[42:43], v[38:39] op_sel:[1,1,0] op_sel_hi:[0,1,1] neg_lo:[1,0,0]
    v_lshlrev_b32 v40, 16, v8
    v_lshlrev_b32 v41, 16, v9
    v_pk_mul_f32 v[40:41], v[40:41], v[14:15] op_sel_hi:[1,0]
    v_mul_f32 v40, 1069066811, v40
    v_mul_f32 v41, 1042479491, v41
    v_exp_f32 v42, v40
    v_fract_f32 v43, v41
    v_cos_f32 v20, v43
    v_sin_f32 v21, v43
    s_nop 0
    v_pk_mul_f32 v[20:21], v[20:21], v[42:43] op_sel_hi:[1,0]
    v_mul_f32 v42, 1090519040, v40
    v_mul_f32 v43, 1090519040, v41
    v_exp_f32 v42, v42
    v_fract_f32 v43, v43
    v_cos_f32 v22, v43
    v_sin_f32 v23, v43
    s_nop 0
    v_pk_mul_f32 v[22:23], v[22:23], v[42:43] op_sel_hi:[1,0]
    v_mul_f32 v42, 1124073472, v40
    v_mul_f32 v43, 1124073472, v41
    v_exp_f32 v42, v42
    v_fract_f32 v43, v43
    v_cos_f32 v24, v43
    v_sin_f32 v25, v43
    s_nop 0
    v_pk_mul_f32 v[24:25], v[24:25], v[42:43] op_sel_hi:[1,0]
    v_and_b32 v64, 0xffff0000, v10
    v_and_b32 v65, 0xffff0000, v11
    v_and_b32 v66, 0xffff0000, v12
    v_and_b32 v67, 0xffff0000, v13
    v_pk_mul_f32 v[64:65], v[64:65], v[14:15] op_sel_hi:[1,0]
    v_pk_mul_f32 v[62:63], v[64:65], v[66:67] op_sel_hi:[1,0]
    v_pk_fma_f32 v[50:51], v[64:65], v[66:67], v[62:63] op_sel:[1,1,0] op_sel_hi:[0,1,1] neg_lo:[1,0,0]
    v_and_b32 v64, 0xffff0000, v8
    v_and_b32 v65, 0xffff0000, v9
    v_pk_mul_f32 v[64:65], v[64:65], v[14:15] op_sel_hi:[1,0]
    v_mul_f32 v64, 1069066811, v64
    v_mul_f32 v65, 1042479491, v65
    v_exp_f32 v66, v64
    v_fract_f32 v67, v65
    v_cos_f32 v44, v67
    v_sin_f32 v45, v67
    s_nop 0
    v_pk_mul_f32 v[44:45], v[44:45], v[66:67] op_sel_hi:[1,0]
    v_mul_f32 v66, 1090519040, v64
    v_mul_f32 v67, 1090519040, v65
    v_exp_f32 v66, v66
    v_fract_f32 v67, v67
    v_cos_f32 v46, v67
    v_sin_f32 v47, v67
    s_nop 0
    v_pk_mul_f32 v[46:47], v[46:47], v[66:67] op_sel_hi:[1,0]
    v_mul_f32 v66, 1124073472, v64
    v_mul_f32 v67, 1124073472, v65
    v_exp_f32 v66, v66
    v_fract_f32 v67, v67
    v_cos_f32 v48, v67
    v_sin_f32 v49, v67
    s_nop 0
    v_pk_mul_f32 v[48:49], v[48:49], v[66:67] op_sel_hi:[1,0]
    v_add_u32 v92, 2112, v6
    v_add_u32 v93, 4224, v6
    v_add_u32 v94, 6336, v6
    v_and_b32 v7, 15, v2
    v_mul_u32_u24 v7, 528, v7
    v_lshrrev_b32 v4, 4, v2
    v_lshl_add_u32 v7, v4, 4, v7
    v_add_u32 v7, s70, v7
    v_cvt_pk_bf16_f32 v70, v26, -v27
    v_cvt_pk_bf16_f32 v71, v50, -v51
    v_pk_mul_f32 v[38:39], v[26:27], v[22:23] op_sel_hi:[1,0]
    v_pk_mul_f32 v[62:63], v[50:51], v[46:47] op_sel_hi:[1,0]
    v_pk_fma_f32 v[26:27], v[26:27], v[22:23], v[38:39] op_sel:[1,1,0] op_sel_hi:[0,1,1] neg_lo:[1,0,0]
    v_pk_fma_f32 v[50:51], v[50:51], v[46:47], v[62:63] op_sel:[1,1,0] op_sel_hi:[0,1,1] neg_lo:[1,0,0]
    v_cvt_pk_bf16_f32 v72, v26, -v27
    v_cvt_pk_bf16_f32 v73, v50, -v51
    ds_write2_b64 v6, v[70:71], v[72:73] offset0:0 offset1:66
    v_pk_mul_f32 v[38:39], v[26:27], v[22:23] op_sel_hi:[1,0]
    v_pk_mul_f32 v[62:63], v[50:51], v[46:47] op_sel_hi:[1,0]
    v_pk_fma_f32 v[26:27], v[26:27], v[22:23], v[38:39] op_sel:[1,1,0] op_sel_hi:[0,1,1] neg_lo:[1,0,0]
    v_pk_fma_f32 v[50:51], v[50:51], v[46:47], v[62:63] op_sel:[1,1,0] op_sel_hi:[0,1,1] neg_lo:[1,0,0]
    v_cvt_pk_bf16_f32 v74, v26, -v27
    v_cvt_pk_bf16_f32 v75, v50, -v51
    v_pk_mul_f32 v[38:39], v[26:27], v[22:23] op_sel_hi:[1,0]
    v_pk_mul_f32 v[62:63], v[50:51], v[46:47] op_sel_hi:[1,0]
    v_pk_fma_f32 v[26:27], v[26:27], v[22:23], v[38:39] op_sel:[1,1,0] op_sel_hi:[0,1,1] neg_lo:[1,0,0]
    v_pk_fma_f32 v[50:51], v[50:51], v[46:47], v[62:63] op_sel:[1,1,0] op_sel_hi:[0,1,1] neg_lo:[1,0,0]
    v_cvt_pk_bf16_f32 v76, v26, -v27
    v_cvt_pk_bf16_f32 v77, v50, -v51
    ds_write2_b64 v6, v[74:75], v[76:77] offset0:132 offset1:198
    v_pk_mul_f32 v[38:39], v[26:27], v[22:23] op_sel_hi:[1,0]
    v_pk_mul_f32 v[62:63], v[50:51], v[46:47] op_sel_hi:[1,0]
    v_pk_fma_f32 v[26:27], v[26:27], v[22:23], v[38:39] op_sel:[1,1,0] op_sel_hi:[0,1,1] neg_lo:[1,0,0]
    v_pk_fma_f32 v[50:51], v[50:51], v[46:47], v[62:63] op_sel:[1,1,0] op_sel_hi:[0,1,1] neg_lo:[1,0,0]
    v_cvt_pk_bf16_f32 v70, v26, -v27
    v_cvt_pk_bf16_f32 v71, v50, -v51
    v_pk_mul_f32 v[38:39], v[26:27], v[22:23] op_sel_hi:[1,0]
    v_pk_mul_f32 v[62:63], v[50:51], v[46:47] op_sel_hi:[1,0]
    v_pk_fma_f32 v[26:27], v[26:27], v[22:23], v[38:39] op_sel:[1,1,0] op_sel_hi:[0,1,1] neg_lo:[1,0,0]
    v_pk_fma_f32 v[50:51], v[50:51], v[46:47], v[62:63] op_sel:[1,1,0] op_sel_hi:[0,1,1] neg_lo:[1,0,0]
    v_cvt_pk_bf16_f32 v72, v26, -v27
    v_cvt_pk_bf16_f32 v73, v50, -v51
    ds_write2_b64 v92, v[70:71], v[72:73] offset0:0 offset1:66
    v_pk_mul_f32 v[38:39], v[26:27], v[22:23] op_sel_hi:[1,0]
    v_pk_mul_f32 v[62:63], v[50:51], v[46:47] op_sel_hi:[1,0]
    v_pk_fma_f32 v[26:27], v[26:27], v[22:23], v[38:39] op_sel:[1,1,0] op_sel_hi:[0,1,1] neg_lo:[1,0,0]
    v_pk_fma_f32 v[50:51], v[50:51], v[46:47], v[62:63] op_sel:[1,1,0] op_sel_hi:[0,1,1] neg_lo:[1,0,0]
    v_cvt_pk_bf16_f32 v74, v26, -v27
    v_cvt_pk_bf16_f32 v75, v50, -v51
    v_pk_mul_f32 v[38:39], v[26:27], v[22:23] op_sel_hi:[1,0]
    v_pk_mul_f32 v[62:63], v[50:51], v[46:47] op_sel_hi:[1,0]
    v_pk_fma_f32 v[26:27], v[26:27], v[22:23], v[38:39] op_sel:[1,1,0] op_sel_hi:[0,1,1] neg_lo:[1,0,0]
    v_pk_fma_f32 v[50:51], v[50:51], v[46:47], v[62:63] op_sel:[1,1,0] op_sel_hi:[0,1,1] neg_lo:[1,0,0]
    v_cvt_pk_bf16_f32 v76, v26, -v27
    v_cvt_pk_bf16_f32 v77, v50, -v51
    ds_write2_b64 v92, v[74:75], v[76:77] offset0:132 offset1:198
    v_pk_mul_f32 v[38:39], v[26:27], v[22:23] op_sel_hi:[1,0]
    v_pk_mul_f32 v[62:63], v[50:51], v[46:47] op_sel_hi:[1,0]
    v_pk_fma_f32 v[26:27], v[26:27], v[22:23], v[38:39] op_sel:[1,1,0] op_sel_hi:[0,1,1] neg_lo:[1,0,0]
    v_pk_fma_f32 v[50:51], v[50:51], v[46:47], v[62:63] op_sel:[1,1,0] op_sel_hi:[0,1,1] neg_lo:[1,0,0]
    v_cvt_pk_bf16_f32 v70, v26, -v27
    v_cvt_pk_bf16_f32 v71, v50, -v51
    v_pk_mul_f32 v[38:39], v[26:27], v[22:23] op_sel_hi:[1,0]
    v_pk_mul_f32 v[62:63], v[50:51], v[46:47] op_sel_hi:[1,0]
    v_pk_fma_f32 v[26:27], v[26:27], v[22:23], v[38:39] op_sel:[1,1,0] op_sel_hi:[0,1,1] neg_lo:[1,0,0]
    v_pk_fma_f32 v[50:51], v[50:51], v[46:47], v[62:63] op_sel:[1,1,0] op_sel_hi:[0,1,1] neg_lo:[1,0,0]
    v_cvt_pk_bf16_f32 v72, v26, -v27
    v_cvt_pk_bf16_f32 v73, v50, -v51
    ds_write2_b64 v93, v[70:71], v[72:73] offset0:0 offset1:66
    v_pk_mul_f32 v[38:39], v[26:27], v[22:23] op_sel_hi:[1,0]
    v_pk_mul_f32 v[62:63], v[50:51], v[46:47] op_sel_hi:[1,0]
    v_pk_fma_f32 v[26:27], v[26:27], v[22:23], v[38:39] op_sel:[1,1,0] op_sel_hi:[0,1,1] neg_lo:[1,0,0]
    v_pk_fma_f32 v[50:51], v[50:51], v[46:47], v[62:63] op_sel:[1,1,0] op_sel_hi:[0,1,1] neg_lo:[1,0,0]
    v_cvt_pk_bf16_f32 v74, v26, -v27
    v_cvt_pk_bf16_f32 v75, v50, -v51
    v_pk_mul_f32 v[38:39], v[26:27], v[22:23] op_sel_hi:[1,0]
    v_pk_mul_f32 v[62:63], v[50:51], v[46:47] op_sel_hi:[1,0]
    v_pk_fma_f32 v[26:27], v[26:27], v[22:23], v[38:39] op_sel:[1,1,0] op_sel_hi:[0,1,1] neg_lo:[1,0,0]
    v_pk_fma_f32 v[50:51], v[50:51], v[46:47], v[62:63] op_sel:[1,1,0] op_sel_hi:[0,1,1] neg_lo:[1,0,0]
    v_cvt_pk_bf16_f32 v76, v26, -v27
    v_cvt_pk_bf16_f32 v77, v50, -v51
    ds_write2_b64 v93, v[74:75], v[76:77] offset0:132 offset1:198
    v_pk_mul_f32 v[38:39], v[26:27], v[22:23] op_sel_hi:[1,0]
    v_pk_mul_f32 v[62:63], v[50:51], v[46:47] op_sel_hi:[1,0]
    v_pk_fma_f32 v[26:27], v[26:27], v[22:23], v[38:39] op_sel:[1,1,0] op_sel_hi:[0,1,1] neg_lo:[1,0,0]
    v_pk_fma_f32 v[50:51], v[50:51], v[46:47], v[62:63] op_sel:[1,1,0] op_sel_hi:[0,1,1] neg_lo:[1,0,0]
    v_cvt_pk_bf16_f32 v70, v26, -v27
    v_cvt_pk_bf16_f32 v71, v50, -v51
    v_pk_mul_f32 v[38:39], v[26:27], v[22:23] op_sel_hi:[1,0]
    v_pk_mul_f32 v[62:63], v[50:51], v[46:47] op_sel_hi:[1,0]
    v_pk_fma_f32 v[26:27], v[26:27], v[22:23], v[38:39] op_sel:[1,1,0] op_sel_hi:[0,1,1] neg_lo:[1,0,0]
    v_pk_fma_f32 v[50:51], v[50:51], v[46:47], v[62:63] op_sel:[1,1,0] op_sel_hi:[0,1,1] neg_lo:[1,0,0]
    v_cvt_pk_bf16_f32 v72, v26, -v27
    v_cvt_pk_bf16_f32 v73, v50, -v51
    ds_write2_b64 v94, v[70:71], v[72:73] offset0:0 offset1:66
    v_pk_mul_f32 v[38:39], v[26:27], v[22:23] op_sel_hi:[1,0]
    v_pk_mul_f32 v[62:63], v[50:51], v[46:47] op_sel_hi:[1,0]
    v_pk_fma_f32 v[26:27], v[26:27], v[22:23], v[38:39] op_sel:[1,1,0] op_sel_hi:[0,1,1] neg_lo:[1,0,0]
    v_pk_fma_f32 v[50:51], v[50:51], v[46:47], v[62:63] op_sel:[1,1,0] op_sel_hi:[0,1,1] neg_lo:[1,0,0]
    v_cvt_pk_bf16_f32 v74, v26, -v27
    v_cvt_pk_bf16_f32 v75, v50, -v51
    v_pk_mul_f32 v[38:39], v[26:27], v[22:23] op_sel_hi:[1,0]
    v_pk_mul_f32 v[62:63], v[50:51], v[46:47] op_sel_hi:[1,0]
    v_pk_fma_f32 v[26:27], v[26:27], v[22:23], v[38:39] op_sel:[1,1,0] op_sel_hi:[0,1,1] neg_lo:[1,0,0]
    v_pk_fma_f32 v[50:51], v[50:51], v[46:47], v[62:63] op_sel:[1,1,0] op_sel_hi:[0,1,1] neg_lo:[1,0,0]
    v_cvt_pk_bf16_f32 v76, v26, -v27
    v_cvt_pk_bf16_f32 v77, v50, -v51
    ds_write2_b64 v94, v[74:75], v[76:77] offset0:132 offset1:198
    ds_read_b128 v[96:99], v7 offset:0
    ds_read_b128 v[100:103], v7 offset:64
    ds_read_b128 v[104:107], v7 offset:128
    ds_read_b128 v[108:111], v7 offset:192
    ds_read_b128 v[112:115], v7 offset:256
    ds_read_b128 v[116:119], v7 offset:320
    ds_read_b128 v[120:123], v7 offset:384
    ds_read_b128 v[124:127], v7 offset:448
    v_mov_b32 v70, 0x3f80
    v_mov_b32 v71, 0x3f80
    v_cvt_pk_bf16_f32 v72, v20, v21
    v_cvt_pk_bf16_f32 v73, v44, v45
    ds_write2_b64 v6, v[70:71], v[72:73] offset0:0 offset1:66
    v_pk_mul_f32 v[38:39], v[20:21], v[20:21] op_sel_hi:[1,0]
    v_pk_mul_f32 v[62:63], v[44:45], v[44:45] op_sel_hi:[1,0]
    v_pk_fma_f32 v[28:29], v[20:21], v[20:21], v[38:39] op_sel:[1,1,0] op_sel_hi:[0,1,1] neg_lo:[1,0,0]
    v_pk_fma_f32 v[52:53], v[44:45], v[44:45], v[62:63] op_sel:[1,1,0] op_sel_hi:[0,1,1] neg_lo:[1,0,0]
    v_cvt_pk_bf16_f32 v74, v28, v29
    v_cvt_pk_bf16_f32 v75, v52, v53
    v_pk_mul_f32 v[38:39], v[28:29], v[20:21] op_sel_hi:[1,0]
    v_pk_mul_f32 v[62:63], v[52:53], v[44:45] op_sel_hi:[1,0]
    v_pk_fma_f32 v[36:37], v[28:29], v[20:21], v[38:39] op_sel:[1,1,0] op_sel_hi:[0,1,1] neg_lo:[1,0,0]
    v_pk_fma_f32 v[60:61], v[52:53], v[44:45], v[62:63] op_sel:[1,1,0] op_sel_hi:[0,1,1] neg_lo:[1,0,0]
    v_cvt_pk_bf16_f32 v76, v36, v37
    v_cvt_pk_bf16_f32 v77, v60, v61
    ds_write2_b64 v6, v[74:75], v[76:77] offset0:132 offset1:198
    v_pk_mul_f32 v[38:39], v[28:29], v[28:29] op_sel_hi:[1,0]
    v_pk_mul_f32 v[62:63], v[52:53], v[52:53] op_sel_hi:[1,0]
    v_pk_fma_f32 v[30:31], v[28:29], v[28:29], v[38:39] op_sel:[1,1,0] op_sel_hi:[0,1,1] neg_lo:[1,0,0]
    v_pk_fma_f32 v[54:55], v[52:53], v[52:53], v[62:63] op_sel:[1,1,0] op_sel_hi:[0,1,1] neg_lo:[1,0,0]
    v_cvt_pk_bf16_f32 v70, v30, v31
    v_cvt_pk_bf16_f32 v71, v54, v55
    v_pk_mul_f32 v[38:39], v[30:31], v[20:21] op_sel_hi:[1,0]
    v_pk_mul_f32 v[62:63], v[54:55], v[44:45] op_sel_hi:[1,0]
    v_pk_fma_f32 v[36:37], v[30:31], v[20:21], v[38:39] op_sel:[1,1,0] op_sel_hi:[0,1,1] neg_lo:[1,0,0]
    v_pk_fma_f32 v[60:61], v[54:55], v[44:45], v[62:63] op_sel:[1,1,0] op_sel_hi:[0,1,1] neg_lo:[1,0,0]
    v_cvt_pk_bf16_f32 v72, v36, v37
    v_cvt_pk_bf16_f32 v73, v60, v61
    ds_write2_b64 v92, v[70:71], v[72:73] offset0:0 offset1:66
    v_pk_mul_f32 v[38:39], v[30:31], v[28:29] op_sel_hi:[1,0]
    v_pk_mul_f32 v[62:63], v[54:55], v[52:53] op_sel_hi:[1,0]
    v_pk_fma_f32 v[32:33], v[30:31], v[28:29], v[38:39] op_sel:[1,1,0] op_sel_hi:[0,1,1] neg_lo:[1,0,0]
    v_pk_fma_f32 v[56:57], v[54:55], v[52:53], v[62:63] op_sel:[1,1,0] op_sel_hi:[0,1,1] neg_lo:[1,0,0]
    v_cvt_pk_bf16_f32 v74, v32, v33
    v_cvt_pk_bf16_f32 v75, v56, v57
    v_pk_mul_f32 v[38:39], v[32:33], v[20:21] op_sel_hi:[1,0]
    v_pk_mul_f32 v[62:63], v[56:57], v[44:45] op_sel_hi:[1,0]
    v_pk_fma_f32 v[36:37], v[32:33], v[20:21], v[38:39] op_sel:[1,1,0] op_sel_hi:[0,1,1] neg_lo:[1,0,0]
    v_pk_fma_f32 v[60:61], v[56:57], v[44:45], v[62:63] op_sel:[1,1,0] op_sel_hi:[0,1,1] neg_lo:[1,0,0]
    v_cvt_pk_bf16_f32 v76, v36, v37
    v_cvt_pk_bf16_f32 v77, v60, v61
    ds_write2_b64 v92, v[74:75], v[76:77] offset0:132 offset1:198
    v_cvt_pk_bf16_f32 v70, v24, v25
    v_cvt_pk_bf16_f32 v71, v48, v49
    v_pk_mul_f32 v[38:39], v[24:25], v[20:21] op_sel_hi:[1,0]
    v_pk_mul_f32 v[62:63], v[48:49], v[44:45] op_sel_hi:[1,0]
    v_pk_fma_f32 v[36:37], v[24:25], v[20:21], v[38:39] op_sel:[1,1,0] op_sel_hi:[0,1,1] neg_lo:[1,0,0]
    v_pk_fma_f32 v[60:61], v[48:49], v[44:45], v[62:63] op_sel:[1,1,0] op_sel_hi:[0,1,1] neg_lo:[1,0,0]
    v_cvt_pk_bf16_f32 v72, v36, v37
    v_cvt_pk_bf16_f32 v73, v60, v61
    ds_write2_b64 v93, v[70:71], v[72:73] offset0:0 offset1:66
    v_pk_mul_f32 v[38:39], v[36:37], v[20:21] op_sel_hi:[1,0]
    v_pk_mul_f32 v[62:63], v[60:61], v[44:45] op_sel_hi:[1,0]
    v_pk_fma_f32 v[36:37], v[36:37], v[20:21], v[38:39] op_sel:[1,1,0] op_sel_hi:[0,1,1] neg_lo:[1,0,0]
    v_pk_fma_f32 v[60:61], v[60:61], v[44:45], v[62:63] op_sel:[1,1,0] op_sel_hi:[0,1,1] neg_lo:[1,0,0]
    v_cvt_pk_bf16_f32 v74, v36, v37
    v_cvt_pk_bf16_f32 v75, v60, v61
    v_pk_mul_f32 v[38:39], v[36:37], v[20:21] op_sel_hi:[1,0]
    v_pk_mul_f32 v[62:63], v[60:61], v[44:45] op_sel_hi:[1,0]
    v_pk_fma_f32 v[36:37], v[36:37], v[20:21], v[38:39] op_sel:[1,1,0] op_sel_hi:[0,1,1] neg_lo:[1,0,0]
    v_pk_fma_f32 v[60:61], v[60:61], v[44:45], v[62:63] op_sel:[1,1,0] op_sel_hi:[0,1,1] neg_lo:[1,0,0]
    v_cvt_pk_bf16_f32 v76, v36, v37
    v_cvt_pk_bf16_f32 v77, v60, v61
    ds_write2_b64 v93, v[74:75], v[76:77] offset0:132 offset1:198
    v_pk_mul_f32 v[38:39], v[36:37], v[20:21] op_sel_hi:[1,0]
    v_pk_mul_f32 v[62:63], v[60:61], v[44:45] op_sel_hi:[1,0]
    v_pk_fma_f32 v[36:37], v[36:37], v[20:21], v[38:39] op_sel:[1,1,0] op_sel_hi:[0,1,1] neg_lo:[1,0,0]
    v_pk_fma_f32 v[60:61], v[60:61], v[44:45], v[62:63] op_sel:[1,1,0] op_sel_hi:[0,1,1] neg_lo:[1,0,0]
    v_cvt_pk_bf16_f32 v70, v36, v37
    v_cvt_pk_bf16_f32 v71, v60, v61
    v_pk_mul_f32 v[38:39], v[36:37], v[20:21] op_sel_hi:[1,0]
    v_pk_mul_f32 v[62:63], v[60:61], v[44:45] op_sel_hi:[1,0]
    v_pk_fma_f32 v[36:37], v[36:37], v[20:21], v[38:39] op_sel:[1,1,0] op_sel_hi:[0,1,1] neg_lo:[1,0,0]
    v_pk_fma_f32 v[60:61], v[60:61], v[44:45], v[62:63] op_sel:[1,1,0] op_sel_hi:[0,1,1] neg_lo:[1,0,0]
    v_cvt_pk_bf16_f32 v72, v36, v37
    v_cvt_pk_bf16_f32 v73, v60, v61
    ds_write2_b64 v94, v[70:71], v[72:73] offset0:0 offset1:66
    v_pk_mul_f32 v[38:39], v[36:37], v[20:21] op_sel_hi:[1,0]
    v_pk_mul_f32 v[62:63], v[60:61], v[44:45] op_sel_hi:[1,0]
    v_pk_fma_f32 v[36:37], v[36:37], v[20:21], v[38:39] op_sel:[1,1,0] op_sel_hi:[0,1,1] neg_lo:[1,0,0]
    v_pk_fma_f32 v[60:61], v[60:61], v[44:45], v[62:63] op_sel:[1,1,0] op_sel_hi:[0,1,1] neg_lo:[1,0,0]
    v_cvt_pk_bf16_f32 v74, v36, v37
    v_cvt_pk_bf16_f32 v75, v60, v61
    v_pk_mul_f32 v[38:39], v[36:37], v[20:21] op_sel_hi:[1,0]
    v_pk_mul_f32 v[62:63], v[60:61], v[44:45] op_sel_hi:[1,0]
    v_pk_fma_f32 v[36:37], v[36:37], v[20:21], v[38:39] op_sel:[1,1,0] op_sel_hi:[0,1,1] neg_lo:[1,0,0]
    v_pk_fma_f32 v[60:61], v[60:61], v[44:45], v[62:63] op_sel:[1,1,0] op_sel_hi:[0,1,1] neg_lo:[1,0,0]
    v_cvt_pk_bf16_f32 v76, v36, v37
    v_cvt_pk_bf16_f32 v77, v60, v61
    ds_write2_b64 v94, v[74:75], v[76:77] offset0:132 offset1:198
    ds_read_b128 v[128:131], v7 offset:0
    ds_read_b128 v[132:135], v7 offset:64
    ds_read_b128 v[136:139], v7 offset:128
    ds_read_b128 v[140:143], v7 offset:192
    ds_read_b128 v[144:147], v7 offset:256
    ds_read_b128 v[148:151], v7 offset:320
    ds_read_b128 v[152:155], v7 offset:384
    ds_read_b128 v[156:159], v7 offset:448
    v_pk_mul_f32 v[38:39], v[24:25], v[24:25] op_sel_hi:[1,0]
    v_pk_mul_f32 v[62:63], v[48:49], v[48:49] op_sel_hi:[1,0]
    v_pk_fma_f32 v[34:35], v[24:25], v[24:25], v[38:39] op_sel:[1,1,0] op_sel_hi:[0,1,1] neg_lo:[1,0,0]
    v_pk_fma_f32 v[58:59], v[48:49], v[48:49], v[62:63] op_sel:[1,1,0] op_sel_hi:[0,1,1] neg_lo:[1,0,0]
    v_cvt_pk_bf16_f32 v70, v34, v35
    v_cvt_pk_bf16_f32 v71, v58, v59
    v_pk_mul_f32 v[38:39], v[34:35], v[28:29] op_sel_hi:[1,0]
    v_pk_mul_f32 v[62:63], v[58:59], v[52:53] op_sel_hi:[1,0]
    v_pk_fma_f32 v[36:37], v[34:35], v[28:29], v[38:39] op_sel:[1,1,0] op_sel_hi:[0,1,1] neg_lo:[1,0,0]
    v_pk_fma_f32 v[60:61], v[58:59], v[52:53], v[62:63] op_sel:[1,1,0] op_sel_hi:[0,1,1] neg_lo:[1,0,0]
    v_cvt_pk_bf16_f32 v72, v36, v37
    v_cvt_pk_bf16_f32 v73, v60, v61
    ds_write2_b64 v6, v[70:71], v[72:73] offset0:0 offset1:66
    v_pk_mul_f32 v[38:39], v[34:35], v[30:31] op_sel_hi:[1,0]
    v_pk_mul_f32 v[62:63], v[58:59], v[54:55] op_sel_hi:[1,0]
    v_pk_fma_f32 v[36:37], v[34:35], v[30:31], v[38:39] op_sel:[1,1,0] op_sel_hi:[0,1,1] neg_lo:[1,0,0]
    v_pk_fma_f32 v[60:61], v[58:59], v[54:55], v[62:63] op_sel:[1,1,0] op_sel_hi:[0,1,1] neg_lo:[1,0,0]
    v_cvt_pk_bf16_f32 v74, v36, v37
    v_cvt_pk_bf16_f32 v75, v60, v61
    v_pk_mul_f32 v[38:39], v[34:35], v[32:33] op_sel_hi:[1,0]
    v_pk_mul_f32 v[62:63], v[58:59], v[56:57] op_sel_hi:[1,0]
    v_pk_fma_f32 v[36:37], v[34:35], v[32:33], v[38:39] op_sel:[1,1,0] op_sel_hi:[0,1,1] neg_lo:[1,0,0]
    v_pk_fma_f32 v[60:61], v[58:59], v[56:57], v[62:63] op_sel:[1,1,0] op_sel_hi:[0,1,1] neg_lo:[1,0,0]
    v_cvt_pk_bf16_f32 v76, v36, v37
    v_cvt_pk_bf16_f32 v77, v60, v61
    ds_write2_b64 v6, v[74:75], v[76:77] offset0:132 offset1:198
    v_pk_mul_f32 v[38:39], v[34:35], v[24:25] op_sel_hi:[1,0]
    v_pk_mul_f32 v[62:63], v[58:59], v[48:49] op_sel_hi:[1,0]
    v_pk_fma_f32 v[34:35], v[34:35], v[24:25], v[38:39] op_sel:[1,1,0] op_sel_hi:[0,1,1] neg_lo:[1,0,0]
    v_pk_fma_f32 v[58:59], v[58:59], v[48:49], v[62:63] op_sel:[1,1,0] op_sel_hi:[0,1,1] neg_lo:[1,0,0]
    s_waitcnt lgkmcnt(9)
    v_mfma_f32_16x16x32_bf16 v[80:83], v[128:131], v[96:99], 0
    s_waitcnt lgkmcnt(8)
    v_mfma_f32_16x16x32_bf16 v[80:83], v[132:135], v[100:103], v[80:83]
    s_waitcnt lgkmcnt(7)
    v_mfma_f32_16x16x32_bf16 v[80:83], v[136:139], v[104:107], v[80:83]
    s_waitcnt lgkmcnt(6)
    v_mfma_f32_16x16x32_bf16 v[80:83], v[140:143], v[108:111], v[80:83]
    s_waitcnt lgkmcnt(5)
    v_mfma_f32_16x16x32_bf16 v[80:83], v[144:147], v[112:115], v[80:83]
    s_waitcnt lgkmcnt(4)
    v_mfma_f32_16x16x32_bf16 v[80:83], v[148:151], v[116:119], v[80:83]
    s_waitcnt lgkmcnt(3)
    v_mfma_f32_16x16x32_bf16 v[80:83], v[152:155], v[120:123], v[80:83]
    s_waitcnt lgkmcnt(2)
    v_mfma_f32_16x16x32_bf16 v[80:83], v[156:159], v[124:127], v[80:83]
    v_cvt_pk_bf16_f32 v70, v34, v35
    v_cvt_pk_bf16_f32 v71, v58, v59
    v_pk_mul_f32 v[38:39], v[34:35], v[28:29] op_sel_hi:[1,0]
    v_pk_mul_f32 v[62:63], v[58:59], v[52:53] op_sel_hi:[1,0]
    v_pk_fma_f32 v[36:37], v[34:35], v[28:29], v[38:39] op_sel:[1,1,0] op_sel_hi:[0,1,1] neg_lo:[1,0,0]
    v_pk_fma_f32 v[60:61], v[58:59], v[52:53], v[62:63] op_sel:[1,1,0] op_sel_hi:[0,1,1] neg_lo:[1,0,0]
    v_cvt_pk_bf16_f32 v72, v36, v37
    v_cvt_pk_bf16_f32 v73, v60, v61
    ds_write2_b64 v92, v[70:71], v[72:73] offset0:0 offset1:66
    v_pk_mul_f32 v[38:39], v[34:35], v[30:31] op_sel_hi:[1,0]
    v_pk_mul_f32 v[62:63], v[58:59], v[54:55] op_sel_hi:[1,0]
    v_pk_fma_f32 v[36:37], v[34:35], v[30:31], v[38:39] op_sel:[1,1,0] op_sel_hi:[0,1,1] neg_lo:[1,0,0]
    v_pk_fma_f32 v[60:61], v[58:59], v[54:55], v[62:63] op_sel:[1,1,0] op_sel_hi:[0,1,1] neg_lo:[1,0,0]
    v_cvt_pk_bf16_f32 v74, v36, v37
    v_cvt_pk_bf16_f32 v75, v60, v61
    v_pk_mul_f32 v[38:39], v[34:35], v[32:33] op_sel_hi:[1,0]
    v_pk_mul_f32 v[62:63], v[58:59], v[56:57] op_sel_hi:[1,0]
    v_pk_fma_f32 v[36:37], v[34:35], v[32:33], v[38:39] op_sel:[1,1,0] op_sel_hi:[0,1,1] neg_lo:[1,0,0]
    v_pk_fma_f32 v[60:61], v[58:59], v[56:57], v[62:63] op_sel:[1,1,0] op_sel_hi:[0,1,1] neg_lo:[1,0,0]
    v_cvt_pk_bf16_f32 v76, v36, v37
    v_cvt_pk_bf16_f32 v77, v60, v61
    ds_write2_b64 v92, v[74:75], v[76:77] offset0:132 offset1:198
    v_pk_mul_f32 v[38:39], v[34:35], v[24:25] op_sel_hi:[1,0]
    v_pk_mul_f32 v[62:63], v[58:59], v[48:49] op_sel_hi:[1,0]
    v_pk_fma_f32 v[34:35], v[34:35], v[24:25], v[38:39] op_sel:[1,1,0] op_sel_hi:[0,1,1] neg_lo:[1,0,0]
    v_pk_fma_f32 v[58:59], v[58:59], v[48:49], v[62:63] op_sel:[1,1,0] op_sel_hi:[0,1,1] neg_lo:[1,0,0]
    v_cvt_pk_bf16_f32 v70, v34, v35
    v_cvt_pk_bf16_f32 v71, v58, v59
    v_pk_mul_f32 v[38:39], v[34:35], v[30:31] op_sel_hi:[1,0]
    v_pk_mul_f32 v[62:63], v[58:59], v[54:55] op_sel_hi:[1,0]
    v_pk_fma_f32 v[36:37], v[34:35], v[30:31], v[38:39] op_sel:[1,1,0] op_sel_hi:[0,1,1] neg_lo:[1,0,0]
    v_pk_fma_f32 v[60:61], v[58:59], v[54:55], v[62:63] op_sel:[1,1,0] op_sel_hi:[0,1,1] neg_lo:[1,0,0]
    v_cvt_pk_bf16_f32 v72, v36, v37
    v_cvt_pk_bf16_f32 v73, v60, v61
    ds_write2_b64 v93, v[70:71], v[72:73] offset0:0 offset1:66
    v_pk_mul_f32 v[38:39], v[34:35], v[24:25] op_sel_hi:[1,0]
    v_pk_mul_f32 v[62:63], v[58:59], v[48:49] op_sel_hi:[1,0]
    v_pk_fma_f32 v[34:35], v[34:35], v[24:25], v[38:39] op_sel:[1,1,0] op_sel_hi:[0,1,1] neg_lo:[1,0,0]
    v_pk_fma_f32 v[58:59], v[58:59], v[48:49], v[62:63] op_sel:[1,1,0] op_sel_hi:[0,1,1] neg_lo:[1,0,0]
    v_cvt_pk_bf16_f32 v74, v34, v35
    v_cvt_pk_bf16_f32 v75, v58, v59
    v_pk_mul_f32 v[38:39], v[34:35], v[30:31] op_sel_hi:[1,0]
    v_pk_mul_f32 v[62:63], v[58:59], v[54:55] op_sel_hi:[1,0]
    v_pk_fma_f32 v[36:37], v[34:35], v[30:31], v[38:39] op_sel:[1,1,0] op_sel_hi:[0,1,1] neg_lo:[1,0,0]
    v_pk_fma_f32 v[60:61], v[58:59], v[54:55], v[62:63] op_sel:[1,1,0] op_sel_hi:[0,1,1] neg_lo:[1,0,0]
    v_cvt_pk_bf16_f32 v76, v36, v37
    v_cvt_pk_bf16_f32 v77, v60, v61
    ds_write2_b64 v93, v[74:75], v[76:77] offset0:132 offset1:198
    v_pk_mul_f32 v[38:39], v[34:35], v[24:25] op_sel_hi:[1,0]
    v_pk_mul_f32 v[62:63], v[58:59], v[48:49] op_sel_hi:[1,0]
    v_pk_fma_f32 v[34:35], v[34:35], v[24:25], v[38:39] op_sel:[1,1,0] op_sel_hi:[0,1,1] neg_lo:[1,0,0]
    v_pk_fma_f32 v[58:59], v[58:59], v[48:49], v[62:63] op_sel:[1,1,0] op_sel_hi:[0,1,1] neg_lo:[1,0,0]
    v_cvt_pk_bf16_f32 v70, v34, v35
    v_cvt_pk_bf16_f32 v71, v58, v59
    v_pk_mul_f32 v[38:39], v[34:35], v[30:31] op_sel_hi:[1,0]
    v_pk_mul_f32 v[62:63], v[58:59], v[54:55] op_sel_hi:[1,0]
    v_pk_fma_f32 v[36:37], v[34:35], v[30:31], v[38:39] op_sel:[1,1,0] op_sel_hi:[0,1,1] neg_lo:[1,0,0]
    v_pk_fma_f32 v[60:61], v[58:59], v[54:55], v[62:63] op_sel:[1,1,0] op_sel_hi:[0,1,1] neg_lo:[1,0,0]
    v_cvt_pk_bf16_f32 v72, v36, v37
    v_cvt_pk_bf16_f32 v73, v60, v61
    ds_write2_b64 v94, v[70:71], v[72:73] offset0:0 offset1:66
    v_pk_mul_f32 v[38:39], v[34:35], v[24:25] op_sel_hi:[1,0]
    v_pk_mul_f32 v[62:63], v[58:59], v[48:49] op_sel_hi:[1,0]
    v_pk_fma_f32 v[34:35], v[34:35], v[24:25], v[38:39] op_sel:[1,1,0] op_sel_hi:[0,1,1] neg_lo:[1,0,0]
    v_pk_fma_f32 v[58:59], v[58:59], v[48:49], v[62:63] op_sel:[1,1,0] op_sel_hi:[0,1,1] neg_lo:[1,0,0]
    v_cvt_pk_bf16_f32 v74, v34, v35
    v_cvt_pk_bf16_f32 v75, v58, v59
    v_pk_mul_f32 v[38:39], v[34:35], v[30:31] op_sel_hi:[1,0]
    v_pk_mul_f32 v[62:63], v[58:59], v[54:55] op_sel_hi:[1,0]
    v_pk_fma_f32 v[36:37], v[34:35], v[30:31], v[38:39] op_sel:[1,1,0] op_sel_hi:[0,1,1] neg_lo:[1,0,0]
    v_pk_fma_f32 v[60:61], v[58:59], v[54:55], v[62:63] op_sel:[1,1,0] op_sel_hi:[0,1,1] neg_lo:[1,0,0]
    v_cvt_pk_bf16_f32 v76, v36, v37
    v_cvt_pk_bf16_f32 v77, v60, v61
    ds_write2_b64 v94, v[74:75], v[76:77] offset0:132 offset1:198
    v_pk_mul_f32 v[38:39], v[34:35], v[24:25] op_sel_hi:[1,0]
    v_pk_mul_f32 v[62:63], v[58:59], v[48:49] op_sel_hi:[1,0]
    v_pk_fma_f32 v[34:35], v[34:35], v[24:25], v[38:39] op_sel:[1,1,0] op_sel_hi:[0,1,1] neg_lo:[1,0,0]
    v_pk_fma_f32 v[58:59], v[58:59], v[48:49], v[62:63] op_sel:[1,1,0] op_sel_hi:[0,1,1] neg_lo:[1,0,0]
    ds_read_b128 v[160:163], v7 offset:0
    ds_read_b128 v[164:167], v7 offset:64
    ds_read_b128 v[168:171], v7 offset:128
    ds_read_b128 v[172:175], v7 offset:192
    ds_read_b128 v[176:179], v7 offset:256
    ds_read_b128 v[180:183], v7 offset:320
    ds_read_b128 v[184:187], v7 offset:384
    ds_read_b128 v[188:191], v7 offset:448
    v_cvt_pk_bf16_f32 v70, v34, v35
    v_cvt_pk_bf16_f32 v71, v58, v59
    v_pk_mul_f32 v[38:39], v[34:35], v[24:25] op_sel_hi:[1,0]
    v_pk_mul_f32 v[62:63], v[58:59], v[48:49] op_sel_hi:[1,0]
    v_pk_fma_f32 v[34:35], v[34:35], v[24:25], v[38:39] op_sel:[1,1,0] op_sel_hi:[0,1,1] neg_lo:[1,0,0]
    v_pk_fma_f32 v[58:59], v[58:59], v[48:49], v[62:63] op_sel:[1,1,0] op_sel_hi:[0,1,1] neg_lo:[1,0,0]
    v_cvt_pk_bf16_f32 v72, v34, v35
    v_cvt_pk_bf16_f32 v73, v58, v59
    ds_write2_b64 v6, v[70:71], v[72:73] offset0:0 offset1:66
    v_pk_mul_f32 v[38:39], v[34:35], v[24:25] op_sel_hi:[1,0]
    v_pk_mul_f32 v[62:63], v[58:59], v[48:49] op_sel_hi:[1,0]
    v_pk_fma_f32 v[34:35], v[34:35], v[24:25], v[38:39] op_sel:[1,1,0] op_sel_hi:[0,1,1] neg_lo:[1,0,0]
    v_pk_fma_f32 v[58:59], v[58:59], v[48:49], v[62:63] op_sel:[1,1,0] op_sel_hi:[0,1,1] neg_lo:[1,0,0]
    v_cvt_pk_bf16_f32 v74, v34, v35
    v_cvt_pk_bf16_f32 v75, v58, v59
    v_pk_mul_f32 v[38:39], v[34:35], v[24:25] op_sel_hi:[1,0]
    v_pk_mul_f32 v[62:63], v[58:59], v[48:49] op_sel_hi:[1,0]
    v_pk_fma_f32 v[34:35], v[34:35], v[24:25], v[38:39] op_sel:[1,1,0] op_sel_hi:[0,1,1] neg_lo:[1,0,0]
    v_pk_fma_f32 v[58:59], v[58:59], v[48:49], v[62:63] op_sel:[1,1,0] op_sel_hi:[0,1,1] neg_lo:[1,0,0]
    v_cvt_pk_bf16_f32 v76, v34, v35
    v_cvt_pk_bf16_f32 v77, v58, v59
    ds_write2_b64 v6, v[74:75], v[76:77] offset0:132 offset1:198
    v_pk_mul_f32 v[38:39], v[34:35], v[24:25] op_sel_hi:[1,0]
    v_pk_mul_f32 v[62:63], v[58:59], v[48:49] op_sel_hi:[1,0]
    v_pk_fma_f32 v[34:35], v[34:35], v[24:25], v[38:39] op_sel:[1,1,0] op_sel_hi:[0,1,1] neg_lo:[1,0,0]
    v_pk_fma_f32 v[58:59], v[58:59], v[48:49], v[62:63] op_sel:[1,1,0] op_sel_hi:[0,1,1] neg_lo:[1,0,0]
    s_waitcnt lgkmcnt(9)
    v_mfma_f32_16x16x32_bf16 v[84:87], v[160:163], v[96:99], 0
    s_waitcnt lgkmcnt(8)
    v_mfma_f32_16x16x32_bf16 v[84:87], v[164:167], v[100:103], v[84:87]
    s_waitcnt lgkmcnt(7)
    v_mfma_f32_16x16x32_bf16 v[84:87], v[168:171], v[104:107], v[84:87]
    s_waitcnt lgkmcnt(6)
    v_mfma_f32_16x16x32_bf16 v[84:87], v[172:175], v[108:111], v[84:87]
    s_waitcnt lgkmcnt(5)
    v_mfma_f32_16x16x32_bf16 v[84:87], v[176:179], v[112:115], v[84:87]
    s_waitcnt lgkmcnt(4)
    v_mfma_f32_16x16x32_bf16 v[84:87], v[180:183], v[116:119], v[84:87]
    s_waitcnt lgkmcnt(3)
    v_mfma_f32_16x16x32_bf16 v[84:87], v[184:187], v[120:123], v[84:87]
    s_waitcnt lgkmcnt(2)
    v_mfma_f32_16x16x32_bf16 v[84:87], v[188:191], v[124:127], v[84:87]
    v_cvt_pk_bf16_f32 v70, v34, v35
    v_cvt_pk_bf16_f32 v71, v58, v59
    v_pk_mul_f32 v[38:39], v[34:35], v[24:25] op_sel_hi:[1,0]
    v_pk_mul_f32 v[62:63], v[58:59], v[48:49] op_sel_hi:[1,0]
    v_pk_fma_f32 v[34:35], v[34:35], v[24:25], v[38:39] op_sel:[1,1,0] op_sel_hi:[0,1,1] neg_lo:[1,0,0]
    v_pk_fma_f32 v[58:59], v[58:59], v[48:49], v[62:63] op_sel:[1,1,0] op_sel_hi:[0,1,1] neg_lo:[1,0,0]
    v_cvt_pk_bf16_f32 v72, v34, v35
    v_cvt_pk_bf16_f32 v73, v58, v59
    ds_write2_b64 v92, v[70:71], v[72:73] offset0:0 offset1:66
    v_pk_mul_f32 v[38:39], v[34:35], v[24:25] op_sel_hi:[1,0]
    v_pk_mul_f32 v[62:63], v[58:59], v[48:49] op_sel_hi:[1,0]
    v_pk_fma_f32 v[34:35], v[34:35], v[24:25], v[38:39] op_sel:[1,1,0] op_sel_hi:[0,1,1] neg_lo:[1,0,0]
    v_pk_fma_f32 v[58:59], v[58:59], v[48:49], v[62:63] op_sel:[1,1,0] op_sel_hi:[0,1,1] neg_lo:[1,0,0]
    v_cvt_pk_bf16_f32 v74, v34, v35
    v_cvt_pk_bf16_f32 v75, v58, v59
    v_pk_mul_f32 v[38:39], v[34:35], v[24:25] op_sel_hi:[1,0]
    v_pk_mul_f32 v[62:63], v[58:59], v[48:49] op_sel_hi:[1,0]
    v_pk_fma_f32 v[34:35], v[34:35], v[24:25], v[38:39] op_sel:[1,1,0] op_sel_hi:[0,1,1] neg_lo:[1,0,0]
    v_pk_fma_f32 v[58:59], v[58:59], v[48:49], v[62:63] op_sel:[1,1,0] op_sel_hi:[0,1,1] neg_lo:[1,0,0]
    v_cvt_pk_bf16_f32 v76, v34, v35
    v_cvt_pk_bf16_f32 v77, v58, v59
    ds_write2_b64 v92, v[74:75], v[76:77] offset0:132 offset1:198
    v_pk_mul_f32 v[38:39], v[34:35], v[24:25] op_sel_hi:[1,0]
    v_pk_mul_f32 v[62:63], v[58:59], v[48:49] op_sel_hi:[1,0]
    v_pk_fma_f32 v[34:35], v[34:35], v[24:25], v[38:39] op_sel:[1,1,0] op_sel_hi:[0,1,1] neg_lo:[1,0,0]
    v_pk_fma_f32 v[58:59], v[58:59], v[48:49], v[62:63] op_sel:[1,1,0] op_sel_hi:[0,1,1] neg_lo:[1,0,0]
    v_cvt_pk_bf16_f32 v70, v34, v35
    v_cvt_pk_bf16_f32 v71, v58, v59
    ds_write_b64 v6, v[70:71] offset:4224
    ds_read_b128 v[128:131], v7 offset:0
    ds_read_b128 v[132:135], v7 offset:64
    ds_read_b128 v[136:139], v7 offset:128
    ds_read_b128 v[140:143], v7 offset:192
    ds_read_b128 v[144:147], v7 offset:256
    ds_read_b128 v[148:151], v7 offset:320
    ds_read_b128 v[152:155], v7 offset:384
    ds_read_b128 v[156:159], v7 offset:448
    s_waitcnt lgkmcnt(7)
    v_mfma_f32_16x16x32_bf16 v[88:91], v[128:131], v[96:99], 0
    s_waitcnt lgkmcnt(6)
    v_mfma_f32_16x16x32_bf16 v[88:91], v[132:135], v[100:103], v[88:91]
    s_waitcnt lgkmcnt(5)
    v_mfma_f32_16x16x32_bf16 v[88:91], v[136:139], v[104:107], v[88:91]
    s_waitcnt lgkmcnt(4)
    v_mfma_f32_16x16x32_bf16 v[88:91], v[140:143], v[108:111], v[88:91]
    s_waitcnt lgkmcnt(3)
    v_mfma_f32_16x16x32_bf16 v[88:91], v[144:147], v[112:115], v[88:91]
    s_waitcnt lgkmcnt(2)
    v_mfma_f32_16x16x32_bf16 v[88:91], v[148:151], v[116:119], v[88:91]
    s_waitcnt lgkmcnt(1)
    v_mfma_f32_16x16x32_bf16 v[88:91], v[152:155], v[120:123], v[88:91]
    s_waitcnt lgkmcnt(0)
    v_mfma_f32_16x16x32_bf16 v[88:91], v[156:159], v[124:127], v[88:91]
    s_setprio 3
    s_setprio 0
    v_mov_b32 v18, 0
    buffer_load_dword v19, v18, s[52:55], 0 offen sc1
    s_waitcnt vmcnt(0)
    v_readfirstlane_b32 s79, v19
    s_mov_b32 s68, 20000
L_non1:
    s_cmp_lg_u32 s79, 0
    s_cbranch_scc1 L_non1_done
    s_sleep 8
    buffer_load_dword v19, v18, s[52:55], 0 offen sc1
    s_waitcnt vmcnt(0)
    v_readfirstlane_b32 s79, v19
    s_sub_u32 s68, s68, 1
    s_cmp_lg_u32 s68, 0
    s_cbranch_scc1 L_non1
L_non1_done:
    s_cmp_lg_u32 s3, 0
    s_cbranch_scc1 L_go2
    s_sub_u32 s13, s2, 256
    s_lshl_b32 s13, s13, 7
    s_add_u32 s13, s13, 327680
    v_mov_b32 v16, s13
    v_mov_b32 v17, 0
    v_cmp_ne_u32 vcc, s79, v17
    s_mov_b32 s68, 20000
L_flg3:
    s_nop 1
    s_cmp_eq_u64 vcc, 0
    s_cbranch_scc1 L_flg3_done
    s_sleep 10
    buffer_load_dword v17, v16, s[48:51], 0 offen sc1
    s_waitcnt vmcnt(0)
    v_cmp_ne_u32 vcc, s79, v17
    s_sub_u32 s68, s68, 1
    s_cmp_lg_u32 s68, 0
    s_cbranch_scc1 L_flg3
L_flg3_done:
L_go2:
    s_barrier
    v_mul_u32_u24 v10, 10240, v0
    s_lshl_b32 s13, s11, 3
    buffer_load_dwordx2 v[96:97], v10, s[56:59], s13 offen offset:0
    buffer_load_dwordx2 v[98:99], v10, s[56:59], s13 offen offset:1280
    buffer_load_dwordx2 v[100:101], v10, s[56:59], s13 offen offset:2560
    s_add_u32 s13, s13, 3840
    buffer_load_dwordx2 v[102:103], v10, s[56:59], s13 offen offset:0
    buffer_load_dwordx2 v[104:105], v10, s[56:59], s13 offen offset:1280
    buffer_load_dwordx2 v[106:107], v10, s[56:59], s13 offen offset:2560
    s_add_u32 s13, s13, 3840
    buffer_load_dwordx2 v[108:109], v10, s[56:59], s13 offen offset:0
    buffer_load_dwordx2 v[110:111], v10, s[56:59], s13 offen offset:1280
    v_mov_b32 v4, 0
    v_mov_b32 v5, 0
    ds_write_b64 v6, v[4:5] offset:8448
    ds_write_b64 v6, v[4:5] offset:13024
    v_and_b32 v8, 15, v2
    v_lshrrev_b32 v9, 4, v2
    v_and_b32 v10, 1, v9
    v_lshlrev_b32 v10, 3, v10
    v_lshrrev_b32 v11, 1, v9
    v_lshl_add_u32 v10, v11, 8, v10
    v_lshl_add_u32 v10, v8, 4, v10
    v_add_u32 v10, s70, v10
    s_cmp_ge_u32 s3, 2
    s_cselect_b32 s14, s77, s76
    s_and_b32 s15, s3, 1
    s_lshl_b32 s15, s15, 4
    s_lshr_b32 s14, s14, s15
    s_lshl_b32 s14, s14, 16
    s_mov_b64 exec, 1
    v_add_f32 v80, s14, v80
    s_mov_b64 exec, -1
    v_cvt_pk_bf16_f32 v70, v80, v81
    v_cvt_pk_bf16_f32 v71, v82, v83
    ds_write_b64 v10, v[70:71] offset:17600
    v_lshlrev_b32 v10, 7, v9
    v_cmp_gt_u32 vcc, 2, v9
    v_lshlrev_b32 v11, 2, v8
    v_lshlrev_b32 v12, 3, v8
    v_cndmask_b32 v11, v11, v12, vcc
    v_add3_u32 v10, v10, v11, s70
    v_mov_b32 v11, 64
    v_mov_b32 v12, 4
    v_cndmask_b32 v11, v11, v12, vcc
    v_add_u32 v11, v10, v11
    v_cvt_pk_bf16_f32 v72, v84, v85
    v_cvt_pk_bf16_f32 v73, v86, v87
    ds_write_b32 v10, v72 offset:18112
    ds_write_b32 v11, v73 offset:18112
    v_lshlrev_b32 v10, 7, v9
    v_lshl_add_u32 v10, v8, 1, v10
    v_add_u32 v10, s70, v10
    v_cvt_pk_bf16_f32 v74, v88, v89
    v_cvt_pk_bf16_f32 v75, v90, v91
    ds_write_b16 v10, v74 offset:18624
    ds_write_b16_d16_hi v10, v74 offset:18656
    ds_write_b16 v10, v75 offset:18688
    ds_write_b16_d16_hi v10, v75 offset:18720
    v_cmp_gt_u32 vcc, 32, v2
    v_lshlrev_b32 v10, 4, v2
    v_lshlrev_b32 v11, 3, v2
    v_add_u32 v11, 256, v11
    v_cndmask_b32 v10, v11, v10, vcc
    v_add_u32 v10, s70, v10
    ds_read_b64 v[20:21], v10 offset:17600
    ds_read_b64 v[22:23], v10 offset:17608
    v_lshl_add_u32 v11, v2, 2, s70
    v_add_u32 v11, 18368, v11
    ds_read2_b32 v[24:25], v11 offset0:0 offset1:1
    v_lshl_add_u32 v11, v2, 1, s70
    ds_read_u16 v26, v11 offset:18624
    ds_read_u16 v27, v11 offset:18626
    ds_read_u16 v28, v11 offset:18752
    ds_read_u16 v29, v11 offset:18754
    v_mov_b32 v12, 16777472
    v_mov_b32 v13, 0x03020100
    v_cndmask_b32 v40, v12, v13, vcc
    v_mov_b32 v41, 0x05040302
    v_mov_b32 v13, 0x07060504
    v_cndmask_b32 v41, v41, v13, vcc
    v_cndmask_b32 v42, v12, v13, vcc
    s_mov_b32 s71, 0x05040302
    s_mov_b32 s72, 16777472
    s_mov_b32 s73, 50463490
    s_waitcnt lgkmcnt(6)
    v_perm_b32 v48, v20, v20, v40
    v_perm_b32 v49, v21, v20, v41
    s_waitcnt lgkmcnt(5)
    v_perm_b32 v50, v22, v21, v42
    v_perm_b32 v51, v22, v21, s71
    v_cndmask_b32 v51, v51, v23, vcc
    s_waitcnt lgkmcnt(4)
    v_perm_b32 v52, v24, v24, s72
    v_mov_b32 v53, v24
    v_perm_b32 v54, v24, v24, s73
    v_perm_b32 v55, v25, v25, s72
    v_and_b32 v13, 1, v2
    v_cmp_eq_u32 vcc, 1, v13
    s_waitcnt lgkmcnt(3)
    v_perm_b32 v56, v26, v26, s72
    v_perm_b32 v57, v26, v26, s72
    s_waitcnt lgkmcnt(2)
    v_cndmask_b32 v13, v26, v27, vcc
    v_lshl_or_b32 v58, v27, 16, v13
    v_perm_b32 v59, v27, v27, s72
    s_waitcnt lgkmcnt(1)
    v_perm_b32 v60, v28, v28, s72
    v_perm_b32 v61, v28, v28, s72
    s_waitcnt lgkmcnt(0)
    v_cndmask_b32 v13, v28, v29, vcc
    v_lshl_or_b32 v62, v29, 16, v13
    v_perm_b32 v63, v29, v29, s72
    v_lshl_add_u32 v10, v2, 4, s70
    ds_write_b128 v10, v[48:51] offset:8896
    ds_write_b128 v10, v[52:55] offset:9920
    ds_write_b128 v10, v[56:59] offset:10944
    ds_write_b128 v10, v[60:63] offset:11968
    v_add_u32 v11, 13476, v10
    ds_write2_b32 v11, v48, v49 offset0:0 offset1:1
    ds_write2_b32 v11, v50, v51 offset0:2 offset1:3
    v_add_u32 v11, 14500, v10
    ds_write2_b32 v11, v52, v53 offset0:0 offset1:1
    ds_write2_b32 v11, v54, v55 offset0:2 offset1:3
    v_add_u32 v11, 15524, v10
    ds_write2_b32 v11, v56, v57 offset0:0 offset1:1
    ds_write2_b32 v11, v58, v59 offset0:2 offset1:3
    v_add_u32 v11, 16548, v10
    ds_write2_b32 v11, v60, v61 offset0:0 offset1:1
    ds_write2_b32 v11, v62, v63 offset0:2 offset1:3
    v_sub_u32 v11, 255, v0
    v_lshlrev_b32 v11, 4, v11
    v_mov_b32 v4, 0
    v_mov_b32 v5, 0
    s_mov_b64 exec, 0xffff
    ds_write_b64 v6, v[4:5] offset:4096
    ds_write_b64 v6, v[4:5] offset:8320
    s_mov_b64 exec, -1
    s_mov_b32 s14, 0x05040100
    s_mov_b32 s15, 0x07060302
    s_waitcnt vmcnt(0)
    v_perm_b32 v112, v108, v110, s14
    v_perm_b32 v113, v104, v106, s14
    v_perm_b32 v114, v100, v102, s14
    v_perm_b32 v115, v96, v98, s14
    ds_write_b128 v11, v[112:115] offset:0
    v_perm_b32 v116, v108, v110, s15
    v_perm_b32 v117, v104, v106, s15
    v_perm_b32 v118, v100, v102, s15
    v_perm_b32 v119, v96, v98, s15
    ds_write_b128 v11, v[116:119] offset:20480
    v_perm_b32 v120, v109, v111, s14
    v_perm_b32 v121, v105, v107, s14
    v_perm_b32 v122, v101, v103, s14
    v_perm_b32 v123, v97, v99, s14
    ds_write_b128 v11, v[120:123] offset:40960
    v_perm_b32 v124, v109, v111, s15
    v_perm_b32 v125, v105, v107, s15
    v_perm_b32 v126, v101, v103, s15
    v_perm_b32 v127, v97, v99, s15
    ds_write_b128 v11, v[124:127] offset:61440
    s_waitcnt lgkmcnt(0)
    s_barrier
    v_lshl_add_u32 v10, v2, 4, s70
    ds_read_b128 v[20:23], v10 offset:0
    ds_read_b32 v24, v10 offset:16
    ds_read_b128 v[26:29], v10 offset:1024
    ds_read_b32 v30, v10 offset:1040
    ds_read_b128 v[32:35], v10 offset:2048
    ds_read_b32 v36, v10 offset:2064
    ds_read_b128 v[38:41], v10 offset:3072
    ds_read_b32 v42, v10 offset:3088
    s_waitcnt lgkmcnt(7)
    v_alignbit_b32 v48, v21, v20, 16
    v_alignbit_b32 v49, v22, v21, 16
    v_alignbit_b32 v50, v23, v22, 16
    s_waitcnt lgkmcnt(6)
    v_alignbit_b32 v51, v24, v23, 16
    ds_write_b128 v10, v[48:51] offset:4224
    s_waitcnt lgkmcnt(6)
    v_alignbit_b32 v52, v27, v26, 16
    v_alignbit_b32 v53, v28, v27, 16
    v_alignbit_b32 v54, v29, v28, 16
    s_waitcnt lgkmcnt(5)
    v_alignbit_b32 v55, v30, v29, 16
    ds_write_b128 v10, v[52:55] offset:5248
    s_waitcnt lgkmcnt(5)
    v_alignbit_b32 v56, v33, v32, 16
    v_alignbit_b32 v57, v34, v33, 16
    v_alignbit_b32 v58, v35, v34, 16
    s_waitcnt lgkmcnt(4)
    v_alignbit_b32 v59, v36, v35, 16
    ds_write_b128 v10, v[56:59] offset:6272
    s_waitcnt lgkmcnt(4)
    v_alignbit_b32 v60, v39, v38, 16
    v_alignbit_b32 v61, v40, v39, 16
    v_alignbit_b32 v62, v41, v40, 16
    s_waitcnt lgkmcnt(3)
    v_alignbit_b32 v63, v42, v41, 16
    ds_write_b128 v10, v[60:63] offset:7296
    v_and_b32 v8, 15, v2
    v_lshrrev_b32 v9, 4, v2
    v_and_b32 v10, 1, v8
    v_lshrrev_b32 v11, 1, v8
    v_xor_b32 v12, 1, v10
    v_mul_u32_u24 v12, 4224, v12
    v_lshl_add_u32 v12, v9, 4, v12
    v_lshlrev_b32 v13, 3, v11
    v_sub_u32 v12, v12, v13
    v_add_u32 v12, 56, v12
    v_add_u32 v12, s70, v12
    v_xor_b32 v13, 1, v10
    v_mul_u32_u24 v13, 4576, v13
    v_lshl_add_u32 v13, v11, 6, v13
    v_lshl_add_u32 v13, v9, 4, v13
    v_add_u32 v13, s70, v13
    v_lshlrev_b32 v20, 6, v11
    v_lshl_add_u32 v20, v10, 2, v20
    v_lshl_add_u32 v20, v9, 4, v20
    v_add_u32 v20, s70, v20
    v_add_u32 v25, 1024, v20
    v_add_u32 v26, 2048, v20
    v_add_u32 v27, 3072, v20
    v_lshlrev_b32 v23, 4, v2
    s_waitcnt lgkmcnt(0)
    ds_read_b128 v[160:163], v13 offset:8896
    ds_read_b64 v[96:97], v12 offset:4032
    ds_read_b64 v[98:99], v12 offset:4040
    ds_read_b128 v[164:167], v13 offset:9408
    ds_read_b64 v[100:101], v12 offset:3520
    ds_read_b64 v[102:103], v12 offset:3528
    ds_read_b128 v[168:171], v13 offset:9920
    ds_read_b64 v[104:105], v12 offset:3008
    ds_read_b64 v[106:107], v12 offset:3016
    ds_read_b128 v[172:175], v13 offset:10432
    ds_read_b64 v[108:109], v12 offset:2496
    ds_read_b64 v[110:111], v12 offset:2504
    ds_read_b128 v[176:179], v13 offset:10944
    ds_read_b64 v[112:113], v12 offset:1984
    ds_read_b64 v[114:115], v12 offset:1992
    ds_read_b128 v[180:183], v13 offset:11456
    ds_read_b64 v[116:117], v12 offset:1472
    ds_read_b64 v[118:119], v12 offset:1480
    ds_read_b128 v[184:187], v13 offset:11968
    ds_read_b64 v[120:121], v12 offset:960
    ds_read_b64 v[122:123], v12 offset:968
    ds_read_b128 v[188:191], v13 offset:12480
    ds_read_b64 v[124:125], v12 offset:448
    ds_read_b64 v[126:127], v12 offset:456
    s_waitcnt lgkmcnt(15)
    v_mfma_f32_16x16x32_bf16 v[64:67], v[96:99], v[160:163], 0
    ds_read_b128 v[192:195], v13 offset:8832
    v_mfma_f32_16x16x32_bf16 v[68:71], v[96:99], v[164:167], 0
    ds_read_b64 v[128:129], v12 offset:3968
    v_mfma_f32_16x16x32_bf16 v[68:71], v[100:103], v[160:163], v[68:71]
    ds_read_b64 v[130:131], v12 offset:3976
    v_mfma_f32_16x16x32_bf16 v[72:75], v[100:103], v[164:167], 0
    ds_read_b128 v[196:199], v13 offset:9344
    v_mfma_f32_16x16x32_bf16 v[72:75], v[96:99], v[168:171], v[72:75]
    ds_read_b64 v[132:133], v12 offset:3456
    v_mfma_f32_16x16x32_bf16 v[76:79], v[100:103], v[168:171], 0
    ds_read_b64 v[134:135], v12 offset:3464
    v_mfma_f32_16x16x32_bf16 v[72:75], v[104:107], v[160:163], v[72:75]
    ds_read_b128 v[200:203], v13 offset:9856
    v_mfma_f32_16x16x32_bf16 v[76:79], v[104:107], v[164:167], v[76:79]
    ds_read_b64 v[136:137], v12 offset:2944
    v_mfma_f32_16x16x32_bf16 v[80:83], v[104:107], v[168:171], 0
    ds_read_b64 v[138:139], v12 offset:2952
    s_waitcnt lgkmcnt(15)
    v_mfma_f32_16x16x32_bf16 v[76:79], v[96:99], v[172:175], v[76:79]
    ds_read_b128 v[204:207], v13 offset:10368
    v_mfma_f32_16x16x32_bf16 v[80:83], v[100:103], v[172:175], v[80:83]
    ds_read_b64 v[140:141], v12 offset:2432
    v_mfma_f32_16x16x32_bf16 v[84:87], v[104:107], v[172:175], 0
    ds_read_b64 v[142:143], v12 offset:2440
    v_mfma_f32_16x16x32_bf16 v[76:79], v[108:111], v[160:163], v[76:79]
    ds_read_b128 v[208:211], v13 offset:10880
    v_mfma_f32_16x16x32_bf16 v[80:83], v[108:111], v[164:167], v[80:83]
    ds_read_b64 v[144:145], v12 offset:1920
    v_mfma_f32_16x16x32_bf16 v[84:87], v[108:111], v[168:171], v[84:87]
    ds_read_b64 v[146:147], v12 offset:1928
    v_mfma_f32_16x16x32_bf16 v[88:91], v[108:111], v[172:175], 0
    ds_read_b128 v[212:215], v13 offset:11392
    v_mfma_f32_16x16x32_bf16 v[80:83], v[96:99], v[176:179], v[80:83]
    ds_read_b64 v[148:149], v12 offset:1408
    v_mfma_f32_16x16x32_bf16 v[84:87], v[100:103], v[176:179], v[84:87]
    ds_read_b64 v[150:151], v12 offset:1416
    v_mfma_f32_16x16x32_bf16 v[88:91], v[104:107], v[176:179], v[88:91]
    ds_read_b128 v[216:219], v13 offset:11904
    v_mfma_f32_16x16x32_bf16 v[92:95], v[108:111], v[176:179], 0
    ds_read_b64 v[152:153], v12 offset:896
    v_mfma_f32_16x16x32_bf16 v[80:83], v[112:115], v[160:163], v[80:83]
    ds_read_b64 v[154:155], v12 offset:904
    v_mfma_f32_16x16x32_bf16 v[84:87], v[112:115], v[164:167], v[84:87]
    ds_read_b128 v[220:223], v13 offset:12416
    v_mfma_f32_16x16x32_bf16 v[88:91], v[112:115], v[168:171], v[88:91]
    ds_read_b64 v[156:157], v12 offset:384
    v_mfma_f32_16x16x32_bf16 v[92:95], v[112:115], v[172:175], v[92:95]
    ds_read_b64 v[158:159], v12 offset:392
    v_mfma_f32_16x16x32_bf16 v[84:87], v[96:99], v[180:183], v[84:87]
    v_mfma_f32_16x16x32_bf16 v[88:91], v[100:103], v[180:183], v[88:91]
    v_mfma_f32_16x16x32_bf16 v[92:95], v[104:107], v[180:183], v[92:95]
    v_mfma_f32_16x16x32_bf16 v[84:87], v[116:119], v[160:163], v[84:87]
    v_mfma_f32_16x16x32_bf16 v[88:91], v[116:119], v[164:167], v[88:91]
    v_mfma_f32_16x16x32_bf16 v[92:95], v[116:119], v[168:171], v[92:95]
    s_waitcnt lgkmcnt(15)
    v_mfma_f32_16x16x32_bf16 v[88:91], v[96:99], v[184:187], v[88:91]
    v_mfma_f32_16x16x32_bf16 v[92:95], v[100:103], v[184:187], v[92:95]
    v_mfma_f32_16x16x32_bf16 v[88:91], v[120:123], v[160:163], v[88:91]
    v_mfma_f32_16x16x32_bf16 v[92:95], v[120:123], v[164:167], v[92:95]
    v_mfma_f32_16x16x32_bf16 v[92:95], v[96:99], v[188:191], v[92:95]
    v_mfma_f32_16x16x32_bf16 v[92:95], v[124:127], v[160:163], v[92:95]
    v_mfma_f32_16x16x32_bf16 v[64:67], v[128:131], v[192:195], v[64:67]
    ds_read_b128 v[160:163], v13 offset:8768
    v_mfma_f32_16x16x32_bf16 v[68:71], v[128:131], v[196:199], v[68:71]
    ds_read_b64 v[96:97], v12 offset:3904
    v_mfma_f32_16x16x32_bf16 v[68:71], v[132:135], v[192:195], v[68:71]
    ds_read_b64 v[98:99], v12 offset:3912
    v_mfma_f32_16x16x32_bf16 v[72:75], v[132:135], v[196:199], v[72:75]
    ds_read_b128 v[164:167], v13 offset:9280
    v_mfma_f32_16x16x32_bf16 v[72:75], v[128:131], v[200:203], v[72:75]
    ds_read_b64 v[100:101], v12 offset:3392
    v_mfma_f32_16x16x32_bf16 v[76:79], v[132:135], v[200:203], v[76:79]
    ds_read_b64 v[102:103], v12 offset:3400
    v_mfma_f32_16x16x32_bf16 v[72:75], v[136:139], v[192:195], v[72:75]
    ds_read_b128 v[168:171], v13 offset:9792
    v_mfma_f32_16x16x32_bf16 v[76:79], v[136:139], v[196:199], v[76:79]
    ds_read_b64 v[104:105], v12 offset:2880
    v_mfma_f32_16x16x32_bf16 v[80:83], v[136:139], v[200:203], v[80:83]
    ds_read_b64 v[106:107], v12 offset:2888
    s_waitcnt lgkmcnt(15)
    v_mfma_f32_16x16x32_bf16 v[76:79], v[128:131], v[204:207], v[76:79]
    ds_read_b128 v[172:175], v13 offset:10304
    v_mfma_f32_16x16x32_bf16 v[80:83], v[132:135], v[204:207], v[80:83]
    ds_read_b64 v[108:109], v12 offset:2368
    v_mfma_f32_16x16x32_bf16 v[84:87], v[136:139], v[204:207], v[84:87]
    ds_read_b64 v[110:111], v12 offset:2376
    v_mfma_f32_16x16x32_bf16 v[76:79], v[140:143], v[192:195], v[76:79]
    ds_read_b128 v[176:179], v13 offset:10816
    v_mfma_f32_16x16x32_bf16 v[80:83], v[140:143], v[196:199], v[80:83]
    ds_read_b64 v[112:113], v12 offset:1856
    v_mfma_f32_16x16x32_bf16 v[84:87], v[140:143], v[200:203], v[84:87]
    ds_read_b64 v[114:115], v12 offset:1864
    v_mfma_f32_16x16x32_bf16 v[88:91], v[140:143], v[204:207], v[88:91]
    ds_read_b128 v[180:183], v13 offset:11328
    v_mfma_f32_16x16x32_bf16 v[80:83], v[128:131], v[208:211], v[80:83]
    ds_read_b64 v[116:117], v12 offset:1344
    v_mfma_f32_16x16x32_bf16 v[84:87], v[132:135], v[208:211], v[84:87]
    ds_read_b64 v[118:119], v12 offset:1352
    v_mfma_f32_16x16x32_bf16 v[88:91], v[136:139], v[208:211], v[88:91]
    ds_read_b128 v[184:187], v13 offset:11840
    v_mfma_f32_16x16x32_bf16 v[92:95], v[140:143], v[208:211], v[92:95]
    ds_read_b64 v[120:121], v12 offset:832
    v_mfma_f32_16x16x32_bf16 v[80:83], v[144:147], v[192:195], v[80:83]
    ds_read_b64 v[122:123], v12 offset:840
    v_mfma_f32_16x16x32_bf16 v[84:87], v[144:147], v[196:199], v[84:87]
    ds_read_b128 v[188:191], v13 offset:12352
    v_mfma_f32_16x16x32_bf16 v[88:91], v[144:147], v[200:203], v[88:91]
    ds_read_b64 v[124:125], v12 offset:320
    v_mfma_f32_16x16x32_bf16 v[92:95], v[144:147], v[204:207], v[92:95]
    ds_read_b64 v[126:127], v12 offset:328
    v_mfma_f32_16x16x32_bf16 v[84:87], v[128:131], v[212:215], v[84:87]
    v_mfma_f32_16x16x32_bf16 v[88:91], v[132:135], v[212:215], v[88:91]
    v_mfma_f32_16x16x32_bf16 v[92:95], v[136:139], v[212:215], v[92:95]
    v_mfma_f32_16x16x32_bf16 v[84:87], v[148:151], v[192:195], v[84:87]
    v_mfma_f32_16x16x32_bf16 v[88:91], v[148:151], v[196:199], v[88:91]
    v_mfma_f32_16x16x32_bf16 v[92:95], v[148:151], v[200:203], v[92:95]
    s_waitcnt lgkmcnt(15)
    v_mfma_f32_16x16x32_bf16 v[88:91], v[128:131], v[216:219], v[88:91]
    v_mfma_f32_16x16x32_bf16 v[92:95], v[132:135], v[216:219], v[92:95]
    v_mfma_f32_16x16x32_bf16 v[88:91], v[152:155], v[192:195], v[88:91]
    v_mfma_f32_16x16x32_bf16 v[92:95], v[152:155], v[196:199], v[92:95]
    v_mfma_f32_16x16x32_bf16 v[92:95], v[128:131], v[220:223], v[92:95]
    v_mfma_f32_16x16x32_bf16 v[92:95], v[156:159], v[192:195], v[92:95]
    v_mfma_f32_16x16x32_bf16 v[64:67], v[96:99], v[160:163], v[64:67]
    ds_read_b128 v[192:195], v13 offset:8704
    v_mfma_f32_16x16x32_bf16 v[68:71], v[96:99], v[164:167], v[68:71]
    ds_read_b64 v[128:129], v12 offset:3840
    v_mfma_f32_16x16x32_bf16 v[68:71], v[100:103], v[160:163], v[68:71]
    ds_read_b64 v[130:131], v12 offset:3848
    v_mfma_f32_16x16x32_bf16 v[72:75], v[100:103], v[164:167], v[72:75]
    ds_read_b128 v[196:199], v13 offset:9216
    v_mfma_f32_16x16x32_bf16 v[72:75], v[96:99], v[168:171], v[72:75]
    ds_read_b64 v[132:133], v12 offset:3328
    v_mfma_f32_16x16x32_bf16 v[76:79], v[100:103], v[168:171], v[76:79]
    ds_read_b64 v[134:135], v12 offset:3336
    v_mfma_f32_16x16x32_bf16 v[72:75], v[104:107], v[160:163], v[72:75]
    ds_read_b128 v[200:203], v13 offset:9728
    v_mfma_f32_16x16x32_bf16 v[76:79], v[104:107], v[164:167], v[76:79]
    ds_read_b64 v[136:137], v12 offset:2816
    v_mfma_f32_16x16x32_bf16 v[80:83], v[104:107], v[168:171], v[80:83]
    ds_read_b64 v[138:139], v12 offset:2824
    s_waitcnt lgkmcnt(15)
    v_mfma_f32_16x16x32_bf16 v[76:79], v[96:99], v[172:175], v[76:79]
    ds_read_b128 v[204:207], v13 offset:10240
    v_mfma_f32_16x16x32_bf16 v[80:83], v[100:103], v[172:175], v[80:83]
    ds_read_b64 v[140:141], v12 offset:2304
    v_mfma_f32_16x16x32_bf16 v[84:87], v[104:107], v[172:175], v[84:87]
    ds_read_b64 v[142:143], v12 offset:2312
    v_mfma_f32_16x16x32_bf16 v[76:79], v[108:111], v[160:163], v[76:79]
    ds_read_b128 v[208:211], v13 offset:10752
    v_mfma_f32_16x16x32_bf16 v[80:83], v[108:111], v[164:167], v[80:83]
    ds_read_b64 v[144:145], v12 offset:1792
    v_mfma_f32_16x16x32_bf16 v[84:87], v[108:111], v[168:171], v[84:87]
    ds_read_b64 v[146:147], v12 offset:1800
    v_mfma_f32_16x16x32_bf16 v[88:91], v[108:111], v[172:175], v[88:91]
    ds_read_b128 v[212:215], v13 offset:11264
    v_mfma_f32_16x16x32_bf16 v[80:83], v[96:99], v[176:179], v[80:83]
    ds_read_b64 v[148:149], v12 offset:1280
    v_mfma_f32_16x16x32_bf16 v[84:87], v[100:103], v[176:179], v[84:87]
    ds_read_b64 v[150:151], v12 offset:1288
    v_mfma_f32_16x16x32_bf16 v[88:91], v[104:107], v[176:179], v[88:91]
    ds_read_b128 v[216:219], v13 offset:11776
    v_mfma_f32_16x16x32_bf16 v[92:95], v[108:111], v[176:179], v[92:95]
    ds_read_b64 v[152:153], v12 offset:768
    v_mfma_f32_16x16x32_bf16 v[80:83], v[112:115], v[160:163], v[80:83]
    ds_read_b64 v[154:155], v12 offset:776
    v_mfma_f32_16x16x32_bf16 v[84:87], v[112:115], v[164:167], v[84:87]
    ds_read_b128 v[220:223], v13 offset:12288
    v_mfma_f32_16x16x32_bf16 v[88:91], v[112:115], v[168:171], v[88:91]
    ds_read_b64 v[156:157], v12 offset:256
    v_mfma_f32_16x16x32_bf16 v[92:95], v[112:115], v[172:175], v[92:95]
    ds_read_b64 v[158:159], v12 offset:264
    v_mfma_f32_16x16x32_bf16 v[84:87], v[96:99], v[180:183], v[84:87]
    v_mfma_f32_16x16x32_bf16 v[88:91], v[100:103], v[180:183], v[88:91]
    v_mfma_f32_16x16x32_bf16 v[92:95], v[104:107], v[180:183], v[92:95]
    v_mfma_f32_16x16x32_bf16 v[84:87], v[116:119], v[160:163], v[84:87]
    v_mfma_f32_16x16x32_bf16 v[88:91], v[116:119], v[164:167], v[88:91]
    v_mfma_f32_16x16x32_bf16 v[92:95], v[116:119], v[168:171], v[92:95]
    s_waitcnt lgkmcnt(15)
    v_mfma_f32_16x16x32_bf16 v[88:91], v[96:99], v[184:187], v[88:91]
    v_mfma_f32_16x16x32_bf16 v[92:95], v[100:103], v[184:187], v[92:95]
    v_mfma_f32_16x16x32_bf16 v[88:91], v[120:123], v[160:163], v[88:91]
    v_mfma_f32_16x16x32_bf16 v[92:95], v[120:123], v[164:167], v[92:95]
    v_mfma_f32_16x16x32_bf16 v[92:95], v[96:99], v[188:191], v[92:95]
    v_mfma_f32_16x16x32_bf16 v[92:95], v[124:127], v[160:163], v[92:95]
    v_mfma_f32_16x16x32_bf16 v[64:67], v[128:131], v[192:195], v[64:67]
    ds_read_b128 v[160:163], v13 offset:8640
    v_mfma_f32_16x16x32_bf16 v[68:71], v[128:131], v[196:199], v[68:71]
    ds_read_b64 v[96:97], v12 offset:3776
    v_mfma_f32_16x16x32_bf16 v[68:71], v[132:135], v[192:195], v[68:71]
    ds_read_b64 v[98:99], v12 offset:3784
    v_mfma_f32_16x16x32_bf16 v[72:75], v[132:135], v[196:199], v[72:75]
    ds_read_b128 v[164:167], v13 offset:9152
    v_mfma_f32_16x16x32_bf16 v[72:75], v[128:131], v[200:203], v[72:75]
    ds_read_b64 v[100:101], v12 offset:3264
    v_mfma_f32_16x16x32_bf16 v[76:79], v[132:135], v[200:203], v[76:79]
    ds_read_b64 v[102:103], v12 offset:3272
    v_mfma_f32_16x16x32_bf16 v[72:75], v[136:139], v[192:195], v[72:75]
    ds_read_b128 v[168:171], v13 offset:9664
    v_mfma_f32_16x16x32_bf16 v[76:79], v[136:139], v[196:199], v[76:79]
    ds_read_b64 v[104:105], v12 offset:2752
    v_mfma_f32_16x16x32_bf16 v[80:83], v[136:139], v[200:203], v[80:83]
    ds_read_b64 v[106:107], v12 offset:2760
    s_waitcnt lgkmcnt(15)
    v_mfma_f32_16x16x32_bf16 v[76:79], v[128:131], v[204:207], v[76:79]
    ds_read_b128 v[172:175], v13 offset:10176
    v_mfma_f32_16x16x32_bf16 v[80:83], v[132:135], v[204:207], v[80:83]
    ds_read_b64 v[108:109], v12 offset:2240
    v_mfma_f32_16x16x32_bf16 v[84:87], v[136:139], v[204:207], v[84:87]
    ds_read_b64 v[110:111], v12 offset:2248
    v_mfma_f32_16x16x32_bf16 v[76:79], v[140:143], v[192:195], v[76:79]
    ds_read_b128 v[176:179], v13 offset:10688
    v_mfma_f32_16x16x32_bf16 v[80:83], v[140:143], v[196:199], v[80:83]
    ds_read_b64 v[112:113], v12 offset:1728
    v_mfma_f32_16x16x32_bf16 v[84:87], v[140:143], v[200:203], v[84:87]
    ds_read_b64 v[114:115], v12 offset:1736
    v_mfma_f32_16x16x32_bf16 v[88:91], v[140:143], v[204:207], v[88:91]
    ds_read_b128 v[180:183], v13 offset:11200
    v_mfma_f32_16x16x32_bf16 v[80:83], v[128:131], v[208:211], v[80:83]
    ds_read_b64 v[116:117], v12 offset:1216
    v_mfma_f32_16x16x32_bf16 v[84:87], v[132:135], v[208:211], v[84:87]
    ds_read_b64 v[118:119], v12 offset:1224
    v_mfma_f32_16x16x32_bf16 v[88:91], v[136:139], v[208:211], v[88:91]
    ds_read_b128 v[184:187], v13 offset:11712
    v_mfma_f32_16x16x32_bf16 v[92:95], v[140:143], v[208:211], v[92:95]
    ds_read_b64 v[120:121], v12 offset:704
    v_mfma_f32_16x16x32_bf16 v[80:83], v[144:147], v[192:195], v[80:83]
    ds_read_b64 v[122:123], v12 offset:712
    v_mfma_f32_16x16x32_bf16 v[84:87], v[144:147], v[196:199], v[84:87]
    ds_read_b128 v[188:191], v13 offset:12224
    v_mfma_f32_16x16x32_bf16 v[88:91], v[144:147], v[200:203], v[88:91]
    ds_read_b64 v[124:125], v12 offset:192
    v_mfma_f32_16x16x32_bf16 v[92:95], v[144:147], v[204:207], v[92:95]
    ds_read_b64 v[126:127], v12 offset:200
    v_mfma_f32_16x16x32_bf16 v[84:87], v[128:131], v[212:215], v[84:87]
    v_mfma_f32_16x16x32_bf16 v[88:91], v[132:135], v[212:215], v[88:91]
    v_mfma_f32_16x16x32_bf16 v[92:95], v[136:139], v[212:215], v[92:95]
    v_mfma_f32_16x16x32_bf16 v[84:87], v[148:151], v[192:195], v[84:87]
    v_mfma_f32_16x16x32_bf16 v[88:91], v[148:151], v[196:199], v[88:91]
    v_mfma_f32_16x16x32_bf16 v[92:95], v[148:151], v[200:203], v[92:95]
    s_waitcnt lgkmcnt(15)
    v_mfma_f32_16x16x32_bf16 v[88:91], v[128:131], v[216:219], v[88:91]
    v_mfma_f32_16x16x32_bf16 v[92:95], v[132:135], v[216:219], v[92:95]
    v_mfma_f32_16x16x32_bf16 v[88:91], v[152:155], v[192:195], v[88:91]
    v_mfma_f32_16x16x32_bf16 v[92:95], v[152:155], v[196:199], v[92:95]
    v_mfma_f32_16x16x32_bf16 v[92:95], v[128:131], v[220:223], v[92:95]
    v_mfma_f32_16x16x32_bf16 v[92:95], v[156:159], v[192:195], v[92:95]
    v_mfma_f32_16x16x32_bf16 v[64:67], v[96:99], v[160:163], v[64:67]
    ds_read_b128 v[192:195], v13 offset:8576
    v_mfma_f32_16x16x32_bf16 v[68:71], v[96:99], v[164:167], v[68:71]
    ds_read_b64 v[128:129], v12 offset:3712
    v_mfma_f32_16x16x32_bf16 v[68:71], v[100:103], v[160:163], v[68:71]
    ds_read_b64 v[130:131], v12 offset:3720
    v_mfma_f32_16x16x32_bf16 v[72:75], v[100:103], v[164:167], v[72:75]
    ds_read_b128 v[196:199], v13 offset:9088
    v_mfma_f32_16x16x32_bf16 v[72:75], v[96:99], v[168:171], v[72:75]
    ds_read_b64 v[132:133], v12 offset:3200
    v_mfma_f32_16x16x32_bf16 v[76:79], v[100:103], v[168:171], v[76:79]
    ds_read_b64 v[134:135], v12 offset:3208
    v_mfma_f32_16x16x32_bf16 v[72:75], v[104:107], v[160:163], v[72:75]
    ds_read_b128 v[200:203], v13 offset:9600
    v_mfma_f32_16x16x32_bf16 v[76:79], v[104:107], v[164:167], v[76:79]
    ds_read_b64 v[136:137], v12 offset:2688
    v_mfma_f32_16x16x32_bf16 v[80:83], v[104:107], v[168:171], v[80:83]
    ds_read_b64 v[138:139], v12 offset:2696
    s_waitcnt lgkmcnt(15)
    v_mfma_f32_16x16x32_bf16 v[76:79], v[96:99], v[172:175], v[76:79]
    ds_read_b128 v[204:207], v13 offset:10112
    v_mfma_f32_16x16x32_bf16 v[80:83], v[100:103], v[172:175], v[80:83]
    ds_read_b64 v[140:141], v12 offset:2176
    v_mfma_f32_16x16x32_bf16 v[84:87], v[104:107], v[172:175], v[84:87]
    ds_read_b64 v[142:143], v12 offset:2184
    v_mfma_f32_16x16x32_bf16 v[76:79], v[108:111], v[160:163], v[76:79]
    ds_read_b128 v[208:211], v13 offset:10624
    v_mfma_f32_16x16x32_bf16 v[80:83], v[108:111], v[164:167], v[80:83]
    ds_read_b64 v[144:145], v12 offset:1664
    v_mfma_f32_16x16x32_bf16 v[84:87], v[108:111], v[168:171], v[84:87]
    ds_read_b64 v[146:147], v12 offset:1672
    v_mfma_f32_16x16x32_bf16 v[88:91], v[108:111], v[172:175], v[88:91]
    ds_read_b128 v[212:215], v13 offset:11136
    v_mfma_f32_16x16x32_bf16 v[80:83], v[96:99], v[176:179], v[80:83]
    ds_read_b64 v[148:149], v12 offset:1152
    v_mfma_f32_16x16x32_bf16 v[84:87], v[100:103], v[176:179], v[84:87]
    ds_read_b64 v[150:151], v12 offset:1160
    v_mfma_f32_16x16x32_bf16 v[88:91], v[104:107], v[176:179], v[88:91]
    ds_read_b128 v[216:219], v13 offset:11648
    v_mfma_f32_16x16x32_bf16 v[92:95], v[108:111], v[176:179], v[92:95]
    ds_read_b64 v[152:153], v12 offset:640
    v_mfma_f32_16x16x32_bf16 v[80:83], v[112:115], v[160:163], v[80:83]
    ds_read_b64 v[154:155], v12 offset:648
    v_mfma_f32_16x16x32_bf16 v[84:87], v[112:115], v[164:167], v[84:87]
    ds_read_b128 v[220:223], v13 offset:12160
    v_mfma_f32_16x16x32_bf16 v[88:91], v[112:115], v[168:171], v[88:91]
    ds_read_b64 v[156:157], v12 offset:128
    v_mfma_f32_16x16x32_bf16 v[92:95], v[112:115], v[172:175], v[92:95]
    ds_read_b64 v[158:159], v12 offset:136
    v_mfma_f32_16x16x32_bf16 v[84:87], v[96:99], v[180:183], v[84:87]
    v_mfma_f32_16x16x32_bf16 v[88:91], v[100:103], v[180:183], v[88:91]
    v_mfma_f32_16x16x32_bf16 v[92:95], v[104:107], v[180:183], v[92:95]
    v_mfma_f32_16x16x32_bf16 v[84:87], v[116:119], v[160:163], v[84:87]
    v_mfma_f32_16x16x32_bf16 v[88:91], v[116:119], v[164:167], v[88:91]
    v_mfma_f32_16x16x32_bf16 v[92:95], v[116:119], v[168:171], v[92:95]
    s_waitcnt lgkmcnt(15)
    v_mfma_f32_16x16x32_bf16 v[88:91], v[96:99], v[184:187], v[88:91]
    v_mfma_f32_16x16x32_bf16 v[92:95], v[100:103], v[184:187], v[92:95]
    v_mfma_f32_16x16x32_bf16 v[88:91], v[120:123], v[160:163], v[88:91]
    v_mfma_f32_16x16x32_bf16 v[92:95], v[120:123], v[164:167], v[92:95]
    v_mfma_f32_16x16x32_bf16 v[92:95], v[96:99], v[188:191], v[92:95]
    v_mfma_f32_16x16x32_bf16 v[92:95], v[124:127], v[160:163], v[92:95]
    v_mfma_f32_16x16x32_bf16 v[64:67], v[128:131], v[192:195], v[64:67]
    ds_read_b128 v[160:163], v13 offset:8512
    v_mfma_f32_16x16x32_bf16 v[68:71], v[128:131], v[196:199], v[68:71]
    ds_read_b64 v[96:97], v12 offset:3648
    v_mfma_f32_16x16x32_bf16 v[68:71], v[132:135], v[192:195], v[68:71]
    ds_read_b64 v[98:99], v12 offset:3656
    v_mfma_f32_16x16x32_bf16 v[72:75], v[132:135], v[196:199], v[72:75]
    ds_read_b128 v[164:167], v13 offset:9024
    v_mfma_f32_16x16x32_bf16 v[72:75], v[128:131], v[200:203], v[72:75]
    ds_read_b64 v[100:101], v12 offset:3136
    v_mfma_f32_16x16x32_bf16 v[76:79], v[132:135], v[200:203], v[76:79]
    ds_read_b64 v[102:103], v12 offset:3144
    v_mfma_f32_16x16x32_bf16 v[72:75], v[136:139], v[192:195], v[72:75]
    ds_read_b128 v[168:171], v13 offset:9536
    v_mfma_f32_16x16x32_bf16 v[76:79], v[136:139], v[196:199], v[76:79]
    ds_read_b64 v[104:105], v12 offset:2624
    v_mfma_f32_16x16x32_bf16 v[80:83], v[136:139], v[200:203], v[80:83]
    ds_read_b64 v[106:107], v12 offset:2632
    s_waitcnt lgkmcnt(15)
    v_mfma_f32_16x16x32_bf16 v[76:79], v[128:131], v[204:207], v[76:79]
    ds_read_b128 v[172:175], v13 offset:10048
    v_mfma_f32_16x16x32_bf16 v[80:83], v[132:135], v[204:207], v[80:83]
    ds_read_b64 v[108:109], v12 offset:2112
    v_mfma_f32_16x16x32_bf16 v[84:87], v[136:139], v[204:207], v[84:87]
    ds_read_b64 v[110:111], v12 offset:2120
    v_mfma_f32_16x16x32_bf16 v[76:79], v[140:143], v[192:195], v[76:79]
    ds_read_b128 v[176:179], v13 offset:10560
    v_mfma_f32_16x16x32_bf16 v[80:83], v[140:143], v[196:199], v[80:83]
    ds_read_b64 v[112:113], v12 offset:1600
    v_mfma_f32_16x16x32_bf16 v[84:87], v[140:143], v[200:203], v[84:87]
    ds_read_b64 v[114:115], v12 offset:1608
    v_mfma_f32_16x16x32_bf16 v[88:91], v[140:143], v[204:207], v[88:91]
    ds_read_b128 v[180:183], v13 offset:11072
    v_mfma_f32_16x16x32_bf16 v[80:83], v[128:131], v[208:211], v[80:83]
    ds_read_b64 v[116:117], v12 offset:1088
    v_mfma_f32_16x16x32_bf16 v[84:87], v[132:135], v[208:211], v[84:87]
    ds_read_b64 v[118:119], v12 offset:1096
    v_mfma_f32_16x16x32_bf16 v[88:91], v[136:139], v[208:211], v[88:91]
    ds_read_b128 v[184:187], v13 offset:11584
    v_mfma_f32_16x16x32_bf16 v[92:95], v[140:143], v[208:211], v[92:95]
    ds_read_b64 v[120:121], v12 offset:576
    v_mfma_f32_16x16x32_bf16 v[80:83], v[144:147], v[192:195], v[80:83]
    ds_read_b64 v[122:123], v12 offset:584
    v_mfma_f32_16x16x32_bf16 v[84:87], v[144:147], v[196:199], v[84:87]
    ds_read_b128 v[188:191], v13 offset:12096
    v_mfma_f32_16x16x32_bf16 v[88:91], v[144:147], v[200:203], v[88:91]
    ds_read_b64 v[124:125], v12 offset:64
    v_mfma_f32_16x16x32_bf16 v[92:95], v[144:147], v[204:207], v[92:95]
    ds_read_b64 v[126:127], v12 offset:72
    v_mfma_f32_16x16x32_bf16 v[84:87], v[128:131], v[212:215], v[84:87]
    v_mfma_f32_16x16x32_bf16 v[88:91], v[132:135], v[212:215], v[88:91]
    v_mfma_f32_16x16x32_bf16 v[92:95], v[136:139], v[212:215], v[92:95]
    v_mfma_f32_16x16x32_bf16 v[84:87], v[148:151], v[192:195], v[84:87]
    v_mfma_f32_16x16x32_bf16 v[88:91], v[148:151], v[196:199], v[88:91]
    v_mfma_f32_16x16x32_bf16 v[92:95], v[148:151], v[200:203], v[92:95]
    s_waitcnt lgkmcnt(15)
    v_mfma_f32_16x16x32_bf16 v[88:91], v[128:131], v[216:219], v[88:91]
    v_mfma_f32_16x16x32_bf16 v[92:95], v[132:135], v[216:219], v[92:95]
    v_mfma_f32_16x16x32_bf16 v[88:91], v[152:155], v[192:195], v[88:91]
    v_mfma_f32_16x16x32_bf16 v[92:95], v[152:155], v[196:199], v[92:95]
    v_mfma_f32_16x16x32_bf16 v[92:95], v[128:131], v[220:223], v[92:95]
    v_mfma_f32_16x16x32_bf16 v[92:95], v[156:159], v[192:195], v[92:95]
    v_mfma_f32_16x16x32_bf16 v[64:67], v[96:99], v[160:163], v[64:67]
    ds_read_b128 v[192:195], v13 offset:8448
    v_mfma_f32_16x16x32_bf16 v[68:71], v[96:99], v[164:167], v[68:71]
    ds_read_b64 v[128:129], v12 offset:3584
    v_mfma_f32_16x16x32_bf16 v[68:71], v[100:103], v[160:163], v[68:71]
    ds_read_b64 v[130:131], v12 offset:3592
    v_mfma_f32_16x16x32_bf16 v[72:75], v[100:103], v[164:167], v[72:75]
    ds_read_b128 v[196:199], v13 offset:8960
    v_mfma_f32_16x16x32_bf16 v[72:75], v[96:99], v[168:171], v[72:75]
    ds_read_b64 v[132:133], v12 offset:3072
    v_mfma_f32_16x16x32_bf16 v[76:79], v[100:103], v[168:171], v[76:79]
    ds_read_b64 v[134:135], v12 offset:3080
    v_mfma_f32_16x16x32_bf16 v[72:75], v[104:107], v[160:163], v[72:75]
    ds_read_b128 v[200:203], v13 offset:9472
    v_mfma_f32_16x16x32_bf16 v[76:79], v[104:107], v[164:167], v[76:79]
    ds_read_b64 v[136:137], v12 offset:2560
    v_mfma_f32_16x16x32_bf16 v[80:83], v[104:107], v[168:171], v[80:83]
    ds_read_b64 v[138:139], v12 offset:2568
    s_waitcnt lgkmcnt(15)
    v_mfma_f32_16x16x32_bf16 v[76:79], v[96:99], v[172:175], v[76:79]
    ds_read_b128 v[204:207], v13 offset:9984
    v_mfma_f32_16x16x32_bf16 v[80:83], v[100:103], v[172:175], v[80:83]
    ds_read_b64 v[140:141], v12 offset:2048
    v_mfma_f32_16x16x32_bf16 v[84:87], v[104:107], v[172:175], v[84:87]
    ds_read_b64 v[142:143], v12 offset:2056
    v_mfma_f32_16x16x32_bf16 v[76:79], v[108:111], v[160:163], v[76:79]
    ds_read_b128 v[208:211], v13 offset:10496
    v_mfma_f32_16x16x32_bf16 v[80:83], v[108:111], v[164:167], v[80:83]
    ds_read_b64 v[144:145], v12 offset:1536
    v_mfma_f32_16x16x32_bf16 v[84:87], v[108:111], v[168:171], v[84:87]
    ds_read_b64 v[146:147], v12 offset:1544
    v_mfma_f32_16x16x32_bf16 v[88:91], v[108:111], v[172:175], v[88:91]
    ds_read_b128 v[212:215], v13 offset:11008
    v_mfma_f32_16x16x32_bf16 v[80:83], v[96:99], v[176:179], v[80:83]
    ds_read_b64 v[148:149], v12 offset:1024
    v_mfma_f32_16x16x32_bf16 v[84:87], v[100:103], v[176:179], v[84:87]
    ds_read_b64 v[150:151], v12 offset:1032
    v_mfma_f32_16x16x32_bf16 v[88:91], v[104:107], v[176:179], v[88:91]
    ds_read_b128 v[216:219], v13 offset:11520
    v_mfma_f32_16x16x32_bf16 v[92:95], v[108:111], v[176:179], v[92:95]
    ds_read_b64 v[152:153], v12 offset:512
    v_mfma_f32_16x16x32_bf16 v[80:83], v[112:115], v[160:163], v[80:83]
    ds_read_b64 v[154:155], v12 offset:520
    v_mfma_f32_16x16x32_bf16 v[84:87], v[112:115], v[164:167], v[84:87]
    ds_read_b128 v[220:223], v13 offset:12032
    v_mfma_f32_16x16x32_bf16 v[88:91], v[112:115], v[168:171], v[88:91]
    ds_read_b64 v[156:157], v12 offset:0
    v_mfma_f32_16x16x32_bf16 v[92:95], v[112:115], v[172:175], v[92:95]
    ds_read_b64 v[158:159], v12 offset:8
    v_mfma_f32_16x16x32_bf16 v[84:87], v[96:99], v[180:183], v[84:87]
    v_mfma_f32_16x16x32_bf16 v[88:91], v[100:103], v[180:183], v[88:91]
    v_mfma_f32_16x16x32_bf16 v[92:95], v[104:107], v[180:183], v[92:95]
    v_mfma_f32_16x16x32_bf16 v[84:87], v[116:119], v[160:163], v[84:87]
    v_mfma_f32_16x16x32_bf16 v[88:91], v[116:119], v[164:167], v[88:91]
    v_mfma_f32_16x16x32_bf16 v[92:95], v[116:119], v[168:171], v[92:95]
    s_waitcnt lgkmcnt(15)
    v_mfma_f32_16x16x32_bf16 v[88:91], v[96:99], v[184:187], v[88:91]
    v_mfma_f32_16x16x32_bf16 v[92:95], v[100:103], v[184:187], v[92:95]
    v_mfma_f32_16x16x32_bf16 v[88:91], v[120:123], v[160:163], v[88:91]
    v_mfma_f32_16x16x32_bf16 v[92:95], v[120:123], v[164:167], v[92:95]
    v_mfma_f32_16x16x32_bf16 v[92:95], v[96:99], v[188:191], v[92:95]
    v_mfma_f32_16x16x32_bf16 v[92:95], v[124:127], v[160:163], v[92:95]
    v_mfma_f32_16x16x32_bf16 v[64:67], v[128:131], v[192:195], v[64:67]
    v_mfma_f32_16x16x32_bf16 v[68:71], v[128:131], v[196:199], v[68:71]
    v_mfma_f32_16x16x32_bf16 v[68:71], v[132:135], v[192:195], v[68:71]
    v_mfma_f32_16x16x32_bf16 v[72:75], v[132:135], v[196:199], v[72:75]
    v_mfma_f32_16x16x32_bf16 v[72:75], v[128:131], v[200:203], v[72:75]
    v_mfma_f32_16x16x32_bf16 v[76:79], v[132:135], v[200:203], v[76:79]
    v_mfma_f32_16x16x32_bf16 v[72:75], v[136:139], v[192:195], v[72:75]
    v_mfma_f32_16x16x32_bf16 v[76:79], v[136:139], v[196:199], v[76:79]
    v_mfma_f32_16x16x32_bf16 v[80:83], v[136:139], v[200:203], v[80:83]
    s_waitcnt lgkmcnt(14)
    v_mfma_f32_16x16x32_bf16 v[76:79], v[128:131], v[204:207], v[76:79]
    v_mfma_f32_16x16x32_bf16 v[80:83], v[132:135], v[204:207], v[80:83]
    v_mfma_f32_16x16x32_bf16 v[84:87], v[136:139], v[204:207], v[84:87]
    s_waitcnt lgkmcnt(12)
    v_mfma_f32_16x16x32_bf16 v[76:79], v[140:143], v[192:195], v[76:79]
    v_mfma_f32_16x16x32_bf16 v[80:83], v[140:143], v[196:199], v[80:83]
    v_mfma_f32_16x16x32_bf16 v[84:87], v[140:143], v[200:203], v[84:87]
    v_mfma_f32_16x16x32_bf16 v[88:91], v[140:143], v[204:207], v[88:91]
    s_waitcnt lgkmcnt(11)
    v_mfma_f32_16x16x32_bf16 v[80:83], v[128:131], v[208:211], v[80:83]
    v_mfma_f32_16x16x32_bf16 v[84:87], v[132:135], v[208:211], v[84:87]
    v_mfma_f32_16x16x32_bf16 v[88:91], v[136:139], v[208:211], v[88:91]
    v_mfma_f32_16x16x32_bf16 v[92:95], v[140:143], v[208:211], v[92:95]
    s_waitcnt lgkmcnt(9)
    v_mfma_f32_16x16x32_bf16 v[80:83], v[144:147], v[192:195], v[80:83]
    v_mfma_f32_16x16x32_bf16 v[84:87], v[144:147], v[196:199], v[84:87]
    v_mfma_f32_16x16x32_bf16 v[88:91], v[144:147], v[200:203], v[88:91]
    v_mfma_f32_16x16x32_bf16 v[92:95], v[144:147], v[204:207], v[92:95]
    s_waitcnt lgkmcnt(8)
    v_mfma_f32_16x16x32_bf16 v[84:87], v[128:131], v[212:215], v[84:87]
    v_mfma_f32_16x16x32_bf16 v[88:91], v[132:135], v[212:215], v[88:91]
    v_mfma_f32_16x16x32_bf16 v[92:95], v[136:139], v[212:215], v[92:95]
    s_waitcnt lgkmcnt(6)
    v_mfma_f32_16x16x32_bf16 v[84:87], v[148:151], v[192:195], v[84:87]
    v_mfma_f32_16x16x32_bf16 v[88:91], v[148:151], v[196:199], v[88:91]
    v_mfma_f32_16x16x32_bf16 v[92:95], v[148:151], v[200:203], v[92:95]
    s_waitcnt lgkmcnt(5)
    v_mfma_f32_16x16x32_bf16 v[88:91], v[128:131], v[216:219], v[88:91]
    v_mfma_f32_16x16x32_bf16 v[92:95], v[132:135], v[216:219], v[92:95]
    s_waitcnt lgkmcnt(3)
    v_mfma_f32_16x16x32_bf16 v[88:91], v[152:155], v[192:195], v[88:91]
    v_mfma_f32_16x16x32_bf16 v[92:95], v[152:155], v[196:199], v[92:95]
    s_waitcnt lgkmcnt(2)
    v_mfma_f32_16x16x32_bf16 v[92:95], v[128:131], v[220:223], v[92:95]
    s_waitcnt lgkmcnt(0)
    v_mfma_f32_16x16x32_bf16 v[92:95], v[156:159], v[192:195], v[92:95]
    s_setprio 0
    v_cvt_pk_bf16_f32 v64, v64, v65
    v_cvt_pk_bf16_f32 v65, v66, v67
    ds_write2_b32 v20, v64, v65 offset0:0 offset1:2
    v_cvt_pk_bf16_f32 v68, v68, v69
    v_cvt_pk_bf16_f32 v69, v70, v71
    ds_write2_b32 v20, v68, v69 offset0:128 offset1:130
    v_cvt_pk_bf16_f32 v72, v72, v73
    v_cvt_pk_bf16_f32 v73, v74, v75
    ds_write2_b32 v25, v72, v73 offset0:0 offset1:2
    v_cvt_pk_bf16_f32 v76, v76, v77
    v_cvt_pk_bf16_f32 v77, v78, v79
    ds_write2_b32 v25, v76, v77 offset0:128 offset1:130
    v_cvt_pk_bf16_f32 v80, v80, v81
    v_cvt_pk_bf16_f32 v81, v82, v83
    ds_write2_b32 v26, v80, v81 offset0:0 offset1:2
    v_cvt_pk_bf16_f32 v84, v84, v85
    v_cvt_pk_bf16_f32 v85, v86, v87
    ds_write2_b32 v26, v84, v85 offset0:128 offset1:130
    v_cvt_pk_bf16_f32 v88, v88, v89
    v_cvt_pk_bf16_f32 v89, v90, v91
    ds_write2_b32 v27, v88, v89 offset0:0 offset1:2
    v_cvt_pk_bf16_f32 v92, v92, v93
    v_cvt_pk_bf16_f32 v93, v94, v95
    ds_write2_b32 v27, v92, v93 offset0:128 offset1:130
    v_lshlrev_b32 v21, 2, v0
    s_mov_b32 s14, 0x05040100
    s_mov_b32 s15, 0x07060302
    s_lshr_b32 s13, s11, 4
    s_lshl_b32 s13, s13, 18
    s_add_u32 s71, s13, 4194304
    s_and_b32 s13, s11, 15
    s_lshl_b32 s13, s13, 10
    s_add_u32 s13, s13, s71
    s_lshl_b32 s72, s3, 14
    s_add_u32 s13, s13, s72
    s_waitcnt lgkmcnt(0)
    s_barrier
    ds_read_b32 v96, v21 offset:0
    ds_read_b32 v97, v21 offset:20480
    ds_read_b32 v98, v21 offset:40960
    ds_read_b32 v99, v21 offset:61440
    ds_read_b32 v100, v21 offset:1024
    ds_read_b32 v101, v21 offset:21504
    ds_read_b32 v102, v21 offset:41984
    ds_read_b32 v103, v21 offset:62464
    ds_read_b32 v104, v21 offset:2048
    ds_read_b32 v105, v21 offset:22528
    ds_read_b32 v106, v21 offset:43008
    ds_read_b32 v107, v21 offset:63488
    ds_read_b32 v108, v21 offset:3072
    ds_read_b32 v109, v21 offset:23552
    ds_read_b32 v110, v21 offset:44032
    ds_read_b32 v111, v21 offset:64512
    s_waitcnt lgkmcnt(14)
    v_perm_b32 v112, v97, v96, s14
    s_waitcnt lgkmcnt(12)
    v_perm_b32 v113, v99, v98, s14
    v_perm_b32 v114, v97, v96, s15
    v_perm_b32 v115, v99, v98, s15
    buffer_store_dwordx4 v[112:115], v23, s[48:51], s13 offen sc1
    s_add_u32 s13, s13, 65536
    s_waitcnt lgkmcnt(10)
    v_perm_b32 v116, v101, v100, s14
    s_waitcnt lgkmcnt(8)
    v_perm_b32 v117, v103, v102, s14
    v_perm_b32 v118, v101, v100, s15
    v_perm_b32 v119, v103, v102, s15
    buffer_store_dwordx4 v[116:119], v23, s[48:51], s13 offen sc1
    s_add_u32 s13, s13, 65536
    s_waitcnt lgkmcnt(6)
    v_perm_b32 v120, v105, v104, s14
    s_waitcnt lgkmcnt(4)
    v_perm_b32 v121, v107, v106, s14
    v_perm_b32 v122, v105, v104, s15
    v_perm_b32 v123, v107, v106, s15
    buffer_store_dwordx4 v[120:123], v23, s[48:51], s13 offen sc1
    s_add_u32 s13, s13, 65536
    s_waitcnt lgkmcnt(2)
    v_perm_b32 v124, v109, v108, s14
    s_waitcnt lgkmcnt(0)
    v_perm_b32 v125, v111, v110, s14
    v_perm_b32 v126, v109, v108, s15
    v_perm_b32 v127, v111, v110, s15
    buffer_store_dwordx4 v[124:127], v23, s[48:51], s13 offen sc1
    v_mul_u32_u24 v8, 288, v2
    s_lshl_b32 s13, s3, 5
    s_add_u32 s13, s13, 8448
    v_add_u32 v8, s13, v8
    v_lshrrev_b32 v9, 3, v0
    v_and_b32 v10, 7, v0
    v_mul_u32_u24 v11, 144, v9
    v_lshl_add_u32 v11, v10, 4, v11
    v_mul_u32_u24 v9, 2560, v9
    v_lshl_add_u32 v9, v10, 4, v9
    s_waitcnt vmcnt(0)
    s_barrier
    s_lshl_b32 s13, s11, 7
    s_add_u32 s13, s13, 307200
    v_mov_b32 v19, s79
    s_mov_b64 exec, 1
    buffer_store_dword v19, v18, s[48:51], s13 offen sc1
    s_mov_b64 exec, -1
    s_and_b32 s13, s11, 0xf0
    v_and_b32 v16, 15, v2
    v_add_u32 v16, s13, v16
    v_lshlrev_b32 v16, 7, v16
    v_add_u32 v16, 307200, v16
    v_mov_b32 v17, 0
    s_cmp_lg_u32 s3, 0
    s_cbranch_scc1 L_gw4
    v_cmp_ne_u32 vcc, s79, v17
    s_mov_b32 s68, 20000
L_flg5:
    s_nop 1
    s_cmp_eq_u64 vcc, 0
    s_cbranch_scc1 L_flg5_done
    s_sleep 4
    buffer_load_dword v17, v16, s[48:51], 0 offen sc1
    s_waitcnt vmcnt(0)
    v_cmp_ne_u32 vcc, s79, v17
    s_sub_u32 s68, s68, 1
    s_cmp_lg_u32 s68, 0
    s_cbranch_scc1 L_flg5
L_flg5_done:
L_gw4:
    s_barrier
    s_and_b32 s13, s11, 15
    s_lshl_b32 s13, s13, 14
    s_add_u32 s13, s13, s71
    s_lshl_b32 s14, s3, 12
    s_add_u32 s13, s13, s14
    buffer_load_dwordx4 v[96:99], v23, s[48:51], s13 offen offset:0 sc1
    buffer_load_dwordx4 v[100:103], v23, s[48:51], s13 offen offset:1024 sc1
    buffer_load_dwordx4 v[104:107], v23, s[48:51], s13 offen offset:2048 sc1
    buffer_load_dwordx4 v[108:111], v23, s[48:51], s13 offen offset:3072 sc1
    s_waitcnt vmcnt(3)
    ds_write_b64 v8, v[96:97] offset:0
    ds_write_b64 v8, v[98:99] offset:144
    s_waitcnt vmcnt(2)
    ds_write_b64 v8, v[100:101] offset:8
    ds_write_b64 v8, v[102:103] offset:152
    s_waitcnt vmcnt(1)
    ds_write_b64 v8, v[104:105] offset:16
    ds_write_b64 v8, v[106:107] offset:160
    s_waitcnt vmcnt(0)
    ds_write_b64 v8, v[108:109] offset:24
    ds_write_b64 v8, v[110:111] offset:168
    s_and_b32 s13, s11, 15
    s_mul_i32 s13, s13, 327680
    s_lshr_b32 s14, s11, 4
    s_lshl_b32 s14, s14, 7
    s_add_u32 s13, s13, s14
    s_waitcnt lgkmcnt(0)
    s_barrier
    ds_read_b128 v[112:115], v11 offset:8448
    ds_read_b128 v[116:119], v11 offset:13056
    ds_read_b128 v[120:123], v11 offset:17664
    ds_read_b128 v[124:127], v11 offset:22272
    s_waitcnt lgkmcnt(3)
    buffer_store_dwordx4 v[112:115], v9, s[64:67], s13 offen
    s_add_u32 s13, s13, 81920
    s_waitcnt lgkmcnt(2)
    buffer_store_dwordx4 v[116:119], v9, s[64:67], s13 offen
    s_add_u32 s13, s13, 81920
    s_waitcnt lgkmcnt(1)
    buffer_store_dwordx4 v[120:123], v9, s[64:67], s13 offen
    s_add_u32 s13, s13, 81920
    s_waitcnt lgkmcnt(0)
    buffer_store_dwordx4 v[124:127], v9, s[64:67], s13 offen
    s_endpgm
L_notA:
    s_cmp_lt_u32 s10, 24
    s_cbranch_scc1 L_roleS
    s_setprio 3
    s_sub_u32 s10, s10, 24
    s_lshl_b32 s11, s10, 3
    s_add_u32 s11, s11, s9
    v_mov_b32 v3, 0
    buffer_load_dword v4, v3, s[52:55], 0 offen sc1
    v_mov_b32 v8, -1
    v_mov_b32 v12, 0
    v_mov_b32 v9, -1
    v_mov_b32 v13, 0
    v_mov_b32 v10, -1
    v_mov_b32 v14, 0
    v_mov_b32 v11, -1
    v_mov_b32 v15, 0
    v_lshlrev_b32 v6, 4, v2
    s_lshl_b32 s12, s11, 2
    s_add_u32 s12, s12, s3
    s_waitcnt vmcnt(0)
    v_readfirstlane_b32 s79, v4
    s_mov_b32 s68, 20000
L_non6:
    s_cmp_lg_u32 s79, 0
    s_cbranch_scc1 L_non6_done
    s_sleep 8
    buffer_load_dword v4, v3, s[52:55], 0 offen sc1
    s_waitcnt vmcnt(0)
    v_readfirstlane_b32 s79, v4
    s_sub_u32 s68, s68, 1
    s_cmp_lg_u32 s68, 0
    s_cbranch_scc1 L_non6
L_non6_done:
    s_mul_i32 s13, s12, 768
    s_mov_b32 exec_hi, 0xffff
    buffer_store_dwordx4 v[12:15], v6, s[48:51], s13 offen sc1
    s_mov_b64 exec, -1
    s_waitcnt vmcnt(0)
    s_barrier
    s_lshl_b32 s13, s11, 7
    s_add_u32 s13, s13, 282624
    v_mov_b32 v4, s79
    s_mov_b64 exec, 1
    buffer_store_dword v4, v3, s[48:51], s13 offen sc1
    s_mov_b64 exec, -1
    s_endpgm
L_roleS:
    s_setprio 3
    s_mov_b32 s60, s40
    s_and_b32 s61, s41, 0xffff
    s_mov_b32 s62, 819200
    s_mov_b32 s63, 0x20000
    v_lshrrev_b32 v5, 4, v2
    v_mul_u32_u24 v5, 1280, v5
    v_and_b32 v4, 15, v2
    v_min_u32 v4, 9, v4
    v_lshl_add_u32 v5, v4, 4, v5
    s_sub_u32 s73, s10, 20
    s_mov_b32 s74, s9
    s_mul_i32 s14, s73, 160
    s_mul_i32 s15, s3, 40
    s_add_u32 s14, s14, s15
    s_mul_i32 s14, s14, 1280
    s_mul_i32 s15, s74, 160
    s_add_u32 s14, s14, s15
    s_mul_i32 s15, s3, 10240
    s_add_u32 s15, s15, 32768
    s_mov_b32 m0, s15
    s_nop 0
    buffer_load_dwordx4 v5, s[60:63], s14 offen lds
    s_add_u32 s14, s14, 5120
    s_add_u32 s15, s15, 1024
    s_mov_b32 m0, s15
    s_nop 0
    buffer_load_dwordx4 v5, s[60:63], s14 offen lds
    s_add_u32 s14, s14, 5120
    s_add_u32 s15, s15, 1024
    s_mov_b32 m0, s15
    s_nop 0
    buffer_load_dwordx4 v5, s[60:63], s14 offen lds
    s_add_u32 s14, s14, 5120
    s_add_u32 s15, s15, 1024
    s_mov_b32 m0, s15
    s_nop 0
    buffer_load_dwordx4 v5, s[60:63], s14 offen lds
    s_add_u32 s14, s14, 5120
    s_add_u32 s15, s15, 1024
    s_mov_b32 m0, s15
    s_nop 0
    buffer_load_dwordx4 v5, s[60:63], s14 offen lds
    s_add_u32 s14, s14, 5120
    s_add_u32 s15, s15, 1024
    s_mov_b32 m0, s15
    s_nop 0
    buffer_load_dwordx4 v5, s[60:63], s14 offen lds
    s_add_u32 s14, s14, 5120
    s_add_u32 s15, s15, 1024
    s_mov_b32 m0, s15
    s_nop 0
    buffer_load_dwordx4 v5, s[60:63], s14 offen lds
    s_add_u32 s14, s14, 5120
    s_add_u32 s15, s15, 1024
    s_mov_b32 m0, s15
    s_nop 0
    buffer_load_dwordx4 v5, s[60:63], s14 offen lds
    s_add_u32 s14, s14, 5120
    s_add_u32 s15, s15, 1024
    s_mov_b32 m0, s15
    s_nop 0
    buffer_load_dwordx4 v5, s[60:63], s14 offen lds
    s_add_u32 s14, s14, 5120
    s_add_u32 s15, s15, 1024
    s_mov_b32 m0, s15
    s_nop 0
    buffer_load_dwordx4 v5, s[60:63], s14 offen lds
    v_lshlrev_b32 v6, 4, v2
    s_waitcnt vmcnt(0)
    s_barrier
    v_and_b32 v58, 3, v2
    v_lshlrev_b32 v59, 3, v58
    v_lshlrev_b32 v58, 4, v58
    s_lshr_b32 s14, s3, 1
    s_lshl_b32 s14, s14, 6
    s_and_b32 s15, s3, 1
    s_lshl_b32 s15, s15, 3
    s_add_u32 s14, s14, s15
    v_lshrrev_b32 v50, 4, v2
    v_lshl_add_u32 v50, s3, 2, v50
    v_mul_u32_u24 v51, 52, v50
    v_lshrrev_b32 v51, 8, v51
    v_mul_u32_u24 v52, 5, v51
    v_sub_u32 v52, v50, v52
    v_bfe_u32 v53, v2, 2, 2
    v_and_b32 v54, 1, v52
    v_lshl_add_u32 v54, v54, 3, 0
    v_lshrrev_b32 v55, 1, v52
    v_cmp_eq_u32 vcc, 4, v52
    v_mov_b32 v56, 16
    v_mov_b32 v57, 0
    v_cndmask_b32 v54, v54, v56, vcc
    v_cndmask_b32 v55, v55, v57, vcc
    v_add_u32 v54, v54, v53
    v_cmp_lt_u32 vcc, 9, v54
    s_nop 1
    v_addc_co_u32 v55, vcc, 0, v55, vcc
    v_mul_u32_u24 v55, 10, v55
    v_add_u32 v54, v54, v55
    v_mul_u32_u24 v51, 40, v51
    v_add_u32 v54, v54, v51
    v_lshlrev_b32 v54, 8, v54
    v_add_u32 v60, 32768, v54
    v_add_u32 v61, v60, v58
    v_add_u32 v62, v60, v59
    ds_read_b64_tr_b16 v[64:65], v61 offset:0
    ds_read_b64_tr_b16 v[68:69], v61 offset:8
    ds_read_b64_tr_b16 v[72:73], v61 offset:64
    ds_read_b64_tr_b16 v[76:77], v61 offset:72
    ds_read_b64_tr_b16 v[80:81], v62 offset:128
    v_lshrrev_b32 v50, 4, v2
    v_add_u32 v50, 16, v50
    v_mul_u32_u24 v51, 52, v50
    v_lshrrev_b32 v51, 8, v51
    v_mul_u32_u24 v52, 5, v51
    v_sub_u32 v52, v50, v52
    v_bfe_u32 v53, v2, 2, 2
    v_and_b32 v54, 1, v52
    v_lshl_add_u32 v54, v54, 3, 0
    v_lshrrev_b32 v55, 1, v52
    v_cmp_eq_u32 vcc, 4, v52
    v_mov_b32 v56, 16
    v_mov_b32 v57, 0
    v_cndmask_b32 v54, v54, v56, vcc
    v_cndmask_b32 v55, v55, v57, vcc
    v_add_u32 v54, v54, v53
    v_cmp_lt_u32 vcc, 9, v54
    s_nop 1
    v_addc_co_u32 v55, vcc, 0, v55, vcc
    v_mul_u32_u24 v55, 10, v55
    v_add_u32 v54, v54, v55
    v_mul_u32_u24 v51, 40, v51
    v_add_u32 v54, v54, v51
    v_lshlrev_b32 v54, 8, v54
    v_add_u32 v60, 32768, v54
    v_add3_u32 v61, v60, v58, s14
    v_add_u32 v62, v60, v59
    ds_read_b64_tr_b16 v[84:85], v61
    ds_read_b64_tr_b16 v[88:89], v62 offset:128
    v_lshrrev_b32 v50, 4, v2
    v_lshl_add_u32 v50, s3, 2, v50
    v_mul_u32_u24 v51, 52, v50
    v_lshrrev_b32 v51, 8, v51
    v_mul_u32_u24 v52, 5, v51
    v_sub_u32 v52, v50, v52
    v_bfe_u32 v53, v2, 2, 2
    v_and_b32 v54, 1, v52
    v_lshl_add_u32 v54, v54, 3, 4
    v_lshrrev_b32 v55, 1, v52
    v_cmp_eq_u32 vcc, 4, v52
    v_mov_b32 v56, 16
    v_mov_b32 v57, 1
    v_cndmask_b32 v54, v54, v56, vcc
    v_cndmask_b32 v55, v55, v57, vcc
    v_add_u32 v54, v54, v53
    v_cmp_lt_u32 vcc, 9, v54
    s_nop 1
    v_addc_co_u32 v55, vcc, 0, v55, vcc
    v_mul_u32_u24 v55, 10, v55
    v_add_u32 v54, v54, v55
    v_mul_u32_u24 v51, 40, v51
    v_add_u32 v54, v54, v51
    v_lshlrev_b32 v54, 8, v54
    v_add_u32 v60, 32768, v54
    v_add_u32 v61, v60, v58
    v_add_u32 v62, v60, v59
    ds_read_b64_tr_b16 v[66:67], v61 offset:0
    ds_read_b64_tr_b16 v[70:71], v61 offset:8
    ds_read_b64_tr_b16 v[74:75], v61 offset:64
    ds_read_b64_tr_b16 v[78:79], v61 offset:72
    ds_read_b64_tr_b16 v[82:83], v62 offset:128
    v_lshrrev_b32 v50, 4, v2
    v_add_u32 v50, 16, v50
    v_mul_u32_u24 v51, 52, v50
    v_lshrrev_b32 v51, 8, v51
    v_mul_u32_u24 v52, 5, v51
    v_sub_u32 v52, v50, v52
    v_bfe_u32 v53, v2, 2, 2
    v_and_b32 v54, 1, v52
    v_lshl_add_u32 v54, v54, 3, 4
    v_lshrrev_b32 v55, 1, v52
    v_cmp_eq_u32 vcc, 4, v52
    v_mov_b32 v56, 16
    v_mov_b32 v57, 1
    v_cndmask_b32 v54, v54, v56, vcc
    v_cndmask_b32 v55, v55, v57, vcc
    v_add_u32 v54, v54, v53
    v_cmp_lt_u32 vcc, 9, v54
    s_nop 1
    v_addc_co_u32 v55, vcc, 0, v55, vcc
    v_mul_u32_u24 v55, 10, v55
    v_add_u32 v54, v54, v55
    v_mul_u32_u24 v51, 40, v51
    v_add_u32 v54, v54, v51
    v_lshlrev_b32 v54, 8, v54
    v_add_u32 v60, 32768, v54
    v_add3_u32 v61, v60, v58, s14
    v_add_u32 v62, v60, v59
    ds_read_b64_tr_b16 v[86:87], v61
    ds_read_b64_tr_b16 v[90:91], v62 offset:128
    s_mul_i32 s14, s74, 20
    s_mul_i32 s15, s73, 5
    s_add_u32 s14, s14, s15
    s_mul_i32 s14, s14, 5120
    s_add_u32 s14, s14, 655360
    s_mul_i32 s15, s3, 5120
    s_add_u32 s15, s15, s14
    s_waitcnt lgkmcnt(6)
    buffer_store_dwordx4 v[64:67], v6, s[48:51], s15 offen offset:0 sc1
    s_waitcnt lgkmcnt(5)
    buffer_store_dwordx4 v[68:71], v6, s[48:51], s15 offen offset:1024 sc1
    s_waitcnt lgkmcnt(4)
    buffer_store_dwordx4 v[72:75], v6, s[48:51], s15 offen offset:2048 sc1
    s_waitcnt lgkmcnt(3)
    buffer_store_dwordx4 v[76:79], v6, s[48:51], s15 offen offset:3072 sc1
    s_add_u32 s15, s15, 4096
    s_waitcnt lgkmcnt(2)
    buffer_store_dwordx4 v[80:83], v6, s[48:51], s15 offen sc1
    s_lshl_b32 s15, s3, 10
    s_add_u32 s15, s15, s14
    s_add_u32 s15, s15, 20480
    s_waitcnt lgkmcnt(1)
    buffer_store_dwordx4 v[84:87], v6, s[48:51], s15 offen sc1
    s_add_u32 s15, s14, 24576
    s_waitcnt lgkmcnt(0)
    buffer_store_dwordx4 v[88:91], v6, s[48:51], s15 offen sc1
    v_mov_b32 v3, 0
    buffer_load_dword v4, v3, s[52:55], 0 offen sc1
    s_waitcnt vmcnt(0)
    s_barrier
    v_readfirstlane_b32 s79, v4
    s_mov_b32 s68, 20000
L_non7:
    s_cmp_lg_u32 s79, 0
    s_cbranch_scc1 L_non7_done
    s_sleep 8
    buffer_load_dword v4, v3, s[52:55], 0 offen sc1
    s_waitcnt vmcnt(0)
    v_readfirstlane_b32 s79, v4
    s_sub_u32 s68, s68, 1
    s_cmp_lg_u32 s68, 0
    s_cbranch_scc1 L_non7
L_non7_done:
    s_lshl_b32 s14, s73, 3
    s_add_u32 s14, s14, s74
    s_lshl_b32 s14, s14, 7
    s_add_u32 s14, s14, 303104
    v_mov_b32 v4, s79
    s_mov_b64 exec, 1
    buffer_store_dword v4, v3, s[48:51], s14 offen sc1
    s_mov_b64 exec, -1
    s_endpgm
L_roleB:
    s_setprio 2
    s_and_b32 s10, s2, 7
    s_lshr_b32 s11, s2, 3
    s_and_b32 s8, s10, 3
    s_lshl_b32 s8, s8, 2
    s_and_b32 s12, s11, 3
    s_add_u32 s8, s8, s12
    s_lshr_b32 s9, s10, 2
    s_lshl_b32 s9, s9, 3
    s_lshr_b32 s13, s11, 2
    s_lshl_b32 s14, s13, 2
    s_lshr_b32 s14, 0x64731520, s14
    s_and_b32 s14, s14, 7
    s_add_u32 s9, s9, s14
    s_xor_b32 s32, s9, 1
    s_mul_i32 s12, s12, 5
    s_lshr_b32 s12, s12, 1
    s_add_u32 s12, s12, s13
    s_and_b32 s13, s10, 1
    s_add_u32 s12, s12, s13
    s_mov_b32 s56, s34
    s_and_b32 s57, s35, 0xffff
    s_mov_b32 s58, 2621440
    s_mov_b32 s59, 0x20000
    s_mov_b32 s60, s36
    s_and_b32 s61, s37, 0xffff
    s_mov_b32 s62, 2457600
    s_mov_b32 s63, 0x20000
    s_sub_u32 s13, s12, 10
    s_cmp_ge_u32 s12, 10
    s_cselect_b32 s16, s13, s12
    s_add_u32 s12, s16, 1
    s_sub_u32 s13, s12, 10
    s_cmp_ge_u32 s12, 10
    s_cselect_b32 s17, s13, s12
    s_add_u32 s12, s17, 1
    v_lshrrev_b32 v3, 3, v2
    v_and_b32 v4, 7, v2
    v_mul_u32_u24 v176, 1280, v3
    v_lshl_add_u32 v176, v4, 4, v176
    s_lshl_b32 s13, s8, 2
    s_add_u32 s13, s13, s3
    s_mul_i32 s13, s13, 40960
    v_add_u32 v176, s13, v176
    v_add_u32 v177, 10240, v176
    v_add_u32 v178, 20480, v176
    v_add_u32 v179, 30720, v176
    s_lshl_b32 s10, s3, 12
    s_lshl_b32 s11, s16, 7
    buffer_load_dwordx4 v[112:115], v176, s[56:59], s11 offen
    buffer_load_dwordx4 v[116:119], v177, s[56:59], s11 offen
    buffer_load_dwordx4 v[120:123], v178, s[56:59], s11 offen
    buffer_load_dwordx4 v[124:127], v179, s[56:59], s11 offen
    v_lshrrev_b32 v5, 4, v2
    v_and_b32 v6, 15, v2
    v_lshlrev_b32 v7, 2, v5
    v_xor_b32 v6, v6, v7
    v_cmp_eq_u32 vcc, 5, v6
    v_lshlrev_b32 v7, 4, v6
    v_mov_b32 v8, 64
    v_cndmask_b32 v7, v7, v8, vcc
    v_cmp_lt_u32 vcc, 5, v6
    s_sub_u32 s13, s9, s32
    s_mul_i32 s13, s13, 80
    s_add_u32 s13, s13, 1184
    v_add_u32 v8, s13, v7
    v_cndmask_b32 v7, v7, v8, vcc
    v_cmp_lt_u32 vcc, 10, v6
    v_add_u32 v8, 1200, v7
    s_nop 0
    v_cndmask_b32 v7, v7, v8, vcc
    v_mul_u32_u24 v5, 3840, v5
    s_mul_i32 s14, s3, 61440
    s_mul_i32 s13, s32, 80
    s_add_u32 s14, s14, s13
    v_add3_u32 v180, v5, v7, s14
    s_mul_i32 s78, s16, 245760
    s_add_u32 m0, s10, 49152
    s_nop 0
    buffer_load_dwordx4 v180, s[60:63], s78 offen lds
    v_add_u32 v181, 15360, v180
    s_add_u32 m0, s10, 50176
    s_nop 0
    buffer_load_dwordx4 v181, s[60:63], s78 offen lds
    v_add_u32 v182, 30720, v180
    s_add_u32 m0, s10, 51200
    s_nop 0
    buffer_load_dwordx4 v182, s[60:63], s78 offen lds
    v_add_u32 v183, 46080, v180
    s_add_u32 m0, s10, 52224
    s_nop 0
    buffer_load_dwordx4 v183, s[60:63], s78 offen lds
    s_lshl_b32 s11, s17, 7
    buffer_load_dwordx4 v[128:131], v176, s[56:59], s11 offen
    buffer_load_dwordx4 v[132:135], v177, s[56:59], s11 offen
    buffer_load_dwordx4 v[136:139], v178, s[56:59], s11 offen
    buffer_load_dwordx4 v[140:143], v179, s[56:59], s11 offen
    s_mul_i32 s78, s17, 245760
    s_add_u32 m0, s10, 0
    s_nop 0
    buffer_load_dwordx4 v180, s[60:63], s78 offen lds
    s_add_u32 m0, s10, 1024
    s_nop 0
    buffer_load_dwordx4 v181, s[60:63], s78 offen lds
    s_add_u32 m0, s10, 2048
    s_nop 0
    buffer_load_dwordx4 v182, s[60:63], s78 offen lds
    s_add_u32 m0, s10, 3072
    s_nop 0
    buffer_load_dwordx4 v183, s[60:63], s78 offen lds
    s_sub_u32 s13, s12, 10
    s_cmp_ge_u32 s12, 10
    s_cselect_b32 s18, s13, s12
    s_add_u32 s12, s18, 1
    s_sub_u32 s13, s12, 10
    s_cmp_ge_u32 s12, 10
    s_cselect_b32 s19, s13, s12
    s_add_u32 s12, s19, 1
    s_sub_u32 s13, s12, 10
    s_cmp_ge_u32 s12, 10
    s_cselect_b32 s20, s13, s12
    s_add_u32 s12, s20, 1
    s_sub_u32 s13, s12, 10
    s_cmp_ge_u32 s12, 10
    s_cselect_b32 s21, s13, s12
    s_add_u32 s12, s21, 1
    s_sub_u32 s13, s12, 10
    s_cmp_ge_u32 s12, 10
    s_cselect_b32 s22, s13, s12
    s_add_u32 s12, s22, 1
    s_sub_u32 s13, s12, 10
    s_cmp_ge_u32 s12, 10
    s_cselect_b32 s23, s13, s12
    s_add_u32 s12, s23, 1
    s_sub_u32 s13, s12, 10
    s_cmp_ge_u32 s12, 10
    s_cselect_b32 s24, s13, s12
    s_add_u32 s12, s24, 1
    s_sub_u32 s13, s12, 10
    s_cmp_ge_u32 s12, 10
    s_cselect_b32 s25, s13, s12
    s_add_u32 s12, s25, 1
    s_add_u32 s13, s10, 65536
    v_lshrrev_b32 v5, 1, v3
    v_xor_b32 v5, v5, v4
    v_lshlrev_b32 v184, 7, v3
    v_lshl_add_u32 v184, v5, 4, v184
    v_add_u32 v184, s13, v184
    v_xor_b32 v185, 64, v184
    v_lshrrev_b32 v11, 5, v2
    v_and_b32 v5, 31, v2
    v_bfe_u32 v6, v2, 1, 3
    v_xor_b32 v6, v6, v11
    v_lshlrev_b32 v186, 7, v5
    v_lshl_add_u32 v186, v6, 4, v186
    v_add_u32 v186, s13, v186
    v_xor_b32 v187, 32, v186
    v_xor_b32 v188, 64, v186
    v_xor_b32 v189, 96, v186
    v_bfe_u32 v5, v2, 2, 2
    v_lshl_add_u32 v12, v11, 3, v5
    v_bfe_u32 v6, v2, 4, 1
    v_and_b32 v7, 3, v2
    v_lshl_add_u32 v13, v6, 2, v7
    v_lshlrev_b32 v190, 8, v12
    v_lshl_add_u32 v190, v13, 3, v190
    v_lshl_add_u32 v190, v5, 6, v190
    v_xor_b32 v191, 64, v190
    v_xor_b32 v192, 128, v190
    v_xor_b32 v193, 192, v190
    s_mov_b32 s26, 0x1fffff
    s_mov_b32 s27, 0x1fffff
    s_mov_b32 s12, 1069066811
    s_mov_b32 s13, 3216550459
    s_mov_b32 s14, 0
    s_mov_b32 s15, -1
    v_mov_b32 v15, 0
    s_waitcnt vmcnt(15)
    ds_write_b128 v184, v[112:115] offset:0
    s_waitcnt vmcnt(14)
    ds_write_b128 v185, v[116:119] offset:1024
    s_waitcnt vmcnt(13)
    ds_write_b128 v184, v[120:123] offset:2048
    s_waitcnt vmcnt(12)
    ds_write_b128 v185, v[124:127] offset:3072
    ds_read_b128 v[112:115], v186
    ds_read_b128 v[116:119], v187
    ds_read_b128 v[120:123], v188
    ds_read_b128 v[124:127], v189
    s_waitcnt vmcnt(8)
    s_barrier
    ds_read_b64_tr_b16 v[80:81], v190 offset:49152
    ds_read_b64_tr_b16 v[82:83], v190 offset:50176
    ds_read_b64_tr_b16 v[84:85], v191 offset:49152
    ds_read_b64_tr_b16 v[86:87], v191 offset:50176
    ds_read_b64_tr_b16 v[88:89], v192 offset:49152
    ds_read_b64_tr_b16 v[90:91], v192 offset:50176
    ds_read_b64_tr_b16 v[92:93], v193 offset:49152
    ds_read_b64_tr_b16 v[94:95], v193 offset:50176
    ds_read_b64_tr_b16 v[96:97], v190 offset:53248
    ds_read_b64_tr_b16 v[98:99], v190 offset:54272
    ds_read_b64_tr_b16 v[100:101], v191 offset:53248
    ds_read_b64_tr_b16 v[102:103], v191 offset:54272
    ds_read_b64_tr_b16 v[104:105], v192 offset:53248
    ds_read_b64_tr_b16 v[106:107], v192 offset:54272
    ds_read_b64_tr_b16 v[108:109], v193 offset:53248
    ds_read_b64_tr_b16 v[110:111], v193 offset:54272
    s_waitcnt lgkmcnt(14)
    v_mfma_f32_32x32x16_bf16 v[16:31], v[80:83], v[112:115], 0
    ds_read_b64_tr_b16 v[80:81], v190 offset:57344
    ds_read_b64_tr_b16 v[82:83], v190 offset:58368
    s_waitcnt vmcnt(7)
    ds_write_b128 v184, v[128:131] offset:0
    s_waitcnt lgkmcnt(15)
    v_mfma_f32_32x32x16_bf16 v[32:47], v[84:87], v[112:115], 0
    ds_read_b64_tr_b16 v[84:85], v191 offset:57344
    ds_read_b64_tr_b16 v[86:87], v191 offset:58368
    s_waitcnt vmcnt(6)
    ds_write_b128 v185, v[132:135] offset:1024
    s_mul_i32 s78, s18, 245760
    s_add_u32 m0, s10, 16384
    s_nop 0
    buffer_load_dwordx4 v180, s[60:63], s78 offen lds
    s_waitcnt lgkmcnt(15)
    v_mfma_f32_32x32x16_bf16 v[48:63], v[88:91], v[112:115], 0
    ds_read_b64_tr_b16 v[88:89], v192 offset:57344
    ds_read_b64_tr_b16 v[90:91], v192 offset:58368
    s_lshl_b32 s11, s18, 7
    buffer_load_dwordx4 v[144:147], v176, s[56:59], s11 offen
    s_waitcnt lgkmcnt(15)
    v_mfma_f32_32x32x16_bf16 v[64:79], v[92:95], v[112:115], 0
    ds_read_b64_tr_b16 v[92:93], v193 offset:57344
    ds_read_b64_tr_b16 v[94:95], v193 offset:58368
    s_add_u32 m0, s10, 17408
    s_nop 0
    buffer_load_dwordx4 v181, s[60:63], s78 offen lds
    buffer_load_dwordx4 v[148:151], v177, s[56:59], s11 offen
    s_waitcnt lgkmcnt(15)
    v_mfma_f32_32x32x16_bf16 v[16:31], v[96:99], v[116:119], v[16:31]
    ds_read_b64_tr_b16 v[96:97], v190 offset:61440
    ds_read_b64_tr_b16 v[98:99], v190 offset:62464
    s_waitcnt vmcnt(9)
    ds_write_b128 v184, v[136:139] offset:2048
    s_waitcnt lgkmcnt(15)
    v_mfma_f32_32x32x16_bf16 v[32:47], v[100:103], v[116:119], v[32:47]
    ds_read_b64_tr_b16 v[100:101], v191 offset:61440
    ds_read_b64_tr_b16 v[102:103], v191 offset:62464
    s_waitcnt vmcnt(8)
    ds_write_b128 v185, v[140:143] offset:3072
    s_add_u32 m0, s10, 18432
    s_nop 0
    buffer_load_dwordx4 v182, s[60:63], s78 offen lds
    v_mfma_f32_32x32x16_bf16 v[48:63], v[104:107], v[116:119], v[48:63]
    ds_read_b64_tr_b16 v[104:105], v192 offset:61440
    ds_read_b64_tr_b16 v[106:107], v192 offset:62464
    buffer_load_dwordx4 v[152:155], v178, s[56:59], s11 offen
    s_waitcnt lgkmcnt(15)
    v_mfma_f32_32x32x16_bf16 v[64:79], v[108:111], v[116:119], v[64:79]
    ds_read_b64_tr_b16 v[108:109], v193 offset:61440
    ds_read_b64_tr_b16 v[110:111], v193 offset:62464
    s_add_u32 m0, s10, 19456
    s_nop 0
    buffer_load_dwordx4 v183, s[60:63], s78 offen lds
    buffer_load_dwordx4 v[156:159], v179, s[56:59], s11 offen
    s_waitcnt vmcnt(8)
    s_barrier
    v_mfma_f32_32x32x16_bf16 v[16:31], v[80:83], v[120:123], v[16:31]
    ds_read_b64_tr_b16 v[80:81], v190 offset:0
    ds_read_b64_tr_b16 v[82:83], v190 offset:1024
    ds_read_b128 v[128:131], v186
    s_waitcnt lgkmcnt(15)
    v_mfma_f32_32x32x16_bf16 v[32:47], v[84:87], v[120:123], v[32:47]
    ds_read_b64_tr_b16 v[84:85], v191 offset:0
    ds_read_b64_tr_b16 v[86:87], v191 offset:1024
    ds_read_b128 v[132:135], v187
    s_mul_i32 s78, s19, 245760
    s_add_u32 m0, s10, 32768
    s_nop 0
    buffer_load_dwordx4 v180, s[60:63], s78 offen lds
    v_mfma_f32_32x32x16_bf16 v[48:63], v[88:91], v[120:123], v[48:63]
    ds_read_b64_tr_b16 v[88:89], v192 offset:0
    ds_read_b64_tr_b16 v[90:91], v192 offset:1024
    s_lshl_b32 s11, s19, 7
    buffer_load_dwordx4 v[160:163], v176, s[56:59], s11 offen
    s_waitcnt lgkmcnt(15)
    v_mfma_f32_32x32x16_bf16 v[64:79], v[92:95], v[120:123], v[64:79]
    ds_read_b64_tr_b16 v[92:93], v193 offset:0
    ds_read_b64_tr_b16 v[94:95], v193 offset:1024
    buffer_load_dwordx4 v[164:167], v177, s[56:59], s11 offen
    v_mfma_f32_32x32x16_bf16 v[16:31], v[96:99], v[124:127], v[16:31]
    ds_read_b64_tr_b16 v[96:97], v190 offset:4096
    ds_read_b64_tr_b16 v[98:99], v190 offset:5120
    ds_read_b128 v[136:139], v188
    s_waitcnt lgkmcnt(15)
    v_mfma_f32_32x32x16_bf16 v[32:47], v[100:103], v[124:127], v[32:47]
    ds_read_b64_tr_b16 v[100:101], v191 offset:4096
    ds_read_b64_tr_b16 v[102:103], v191 offset:5120
    ds_read_b128 v[140:143], v189
    s_add_u32 m0, s10, 33792
    s_nop 0
    buffer_load_dwordx4 v181, s[60:63], s78 offen lds
    v_mfma_f32_32x32x16_bf16 v[48:63], v[104:107], v[124:127], v[48:63]
    ds_read_b64_tr_b16 v[104:105], v192 offset:4096
    ds_read_b64_tr_b16 v[106:107], v192 offset:5120
    buffer_load_dwordx4 v[168:171], v178, s[56:59], s11 offen
    s_waitcnt lgkmcnt(15)
    v_mfma_f32_32x32x16_bf16 v[64:79], v[108:111], v[124:127], v[64:79]
    ds_read_b64_tr_b16 v[108:109], v193 offset:4096
    ds_read_b64_tr_b16 v[110:111], v193 offset:5120
    buffer_load_dwordx4 v[172:175], v179, s[56:59], s11 offen
    v_mfma_f32_32x32x16_bf16 v[16:31], v[80:83], v[128:131], v[16:31]
    ds_read_b64_tr_b16 v[80:81], v190 offset:8192
    ds_read_b64_tr_b16 v[82:83], v190 offset:9216
    s_waitcnt vmcnt(12)
    ds_write_b128 v184, v[144:147] offset:0
    s_waitcnt lgkmcnt(15)
    v_mfma_f32_32x32x16_bf16 v[32:47], v[84:87], v[128:131], v[32:47]
    ds_read_b64_tr_b16 v[84:85], v191 offset:8192
    ds_read_b64_tr_b16 v[86:87], v191 offset:9216
    s_waitcnt vmcnt(10)
    ds_write_b128 v185, v[148:151] offset:1024
    s_add_u32 m0, s10, 34816
    s_nop 0
    buffer_load_dwordx4 v182, s[60:63], s78 offen lds
    v_mfma_f32_32x32x16_bf16 v[48:63], v[88:91], v[128:131], v[48:63]
    ds_read_b64_tr_b16 v[88:89], v192 offset:8192
    ds_read_b64_tr_b16 v[90:91], v192 offset:9216
    s_lshl_b32 s11, s20, 7
    buffer_load_dwordx4 v[112:115], v176, s[56:59], s11 offen
    s_waitcnt lgkmcnt(15)
    v_mfma_f32_32x32x16_bf16 v[64:79], v[92:95], v[128:131], v[64:79]
    ds_read_b64_tr_b16 v[92:93], v193 offset:8192
    ds_read_b64_tr_b16 v[94:95], v193 offset:9216
    v_mfma_f32_32x32x16_bf16 v[16:31], v[96:99], v[132:135], v[16:31]
    ds_read_b64_tr_b16 v[96:97], v190 offset:12288
    ds_read_b64_tr_b16 v[98:99], v190 offset:13312
    s_waitcnt vmcnt(10)
    ds_write_b128 v184, v[152:155] offset:2048
    s_waitcnt lgkmcnt(15)
    v_mfma_f32_32x32x16_bf16 v[32:47], v[100:103], v[132:135], v[32:47]
    ds_read_b64_tr_b16 v[100:101], v191 offset:12288
    ds_read_b64_tr_b16 v[102:103], v191 offset:13312
    s_waitcnt vmcnt(8)
    ds_write_b128 v185, v[156:159] offset:3072
    s_add_u32 m0, s10, 35840
    s_nop 0
    buffer_load_dwordx4 v183, s[60:63], s78 offen lds
    v_mfma_f32_32x32x16_bf16 v[48:63], v[104:107], v[132:135], v[48:63]
    ds_read_b64_tr_b16 v[104:105], v192 offset:12288
    ds_read_b64_tr_b16 v[106:107], v192 offset:13312
    buffer_load_dwordx4 v[116:119], v177, s[56:59], s11 offen
    s_waitcnt lgkmcnt(15)
    v_mfma_f32_32x32x16_bf16 v[64:79], v[108:111], v[132:135], v[64:79]
    ds_read_b64_tr_b16 v[108:109], v193 offset:12288
    ds_read_b64_tr_b16 v[110:111], v193 offset:13312
    v_and_b32 v200, 31, v2
    v_mul_u32_u24 v3, 37, v200
    v_lshrrev_b32 v3, 8, v3
    v_add_u32 v3, v3, v200
    v_cmp_gt_u32 vcc, 21, v200
    v_mul_u32_u24 v200, 8, v200
    v_subrev_u32 v200, 161, v200
    v_cndmask_b32 v200, v200, v3, vcc
    v_mul_u32_u24 v3, 24, v11
    v_add_lshl_u32 v200, v200, v3, 2
    s_mul_i32 s70, s9, 12288
    s_mul_i32 s71, s3, 3072
    s_add_u32 s70, s70, s71
    v_bfe_u32 v3, v2, 4, 1
    v_mul_u32_u24 v3, 20480, v3
    v_and_b32 v205, 15, v2
    v_lshl_add_u32 v3, v205, 4, v3
    v_lshrrev_b32 v206, 5, v2
    v_lshl_add_u32 v205, v206, 9, v3
    v_lshl_add_u32 v206, v206, 3, v3
    s_lshl_b32 s72, s8, 2
    s_add_u32 s72, s72, s3
    s_mul_i32 s72, s72, 40960
    s_mul_i32 s73, s32, 1280
    s_add_u32 s72, s72, s73
    s_add_u32 s72, s72, 1572864
    v_mov_b32 v212, -1
    v_mov_b32 v213, -1
    v_mov_b32 v214, -1
    v_mov_b32 v215, -1
    s_barrier
    v_mfma_f32_32x32x16_bf16 v[16:31], v[80:83], v[136:139], v[16:31]
    ds_read_b64_tr_b16 v[80:81], v190 offset:16384
    ds_read_b64_tr_b16 v[82:83], v190 offset:17408
    ds_read_b128 v[144:147], v186
    s_waitcnt lgkmcnt(15)
    v_mfma_f32_32x32x16_bf16 v[32:47], v[84:87], v[136:139], v[32:47]
    ds_read_b64_tr_b16 v[84:85], v191 offset:16384
    ds_read_b64_tr_b16 v[86:87], v191 offset:17408
    ds_read_b128 v[148:151], v187
    s_mul_i32 s78, s20, 245760
    s_add_u32 m0, s10, 49152
    s_nop 0
    buffer_load_dwordx4 v180, s[60:63], s78 offen lds
    v_mfma_f32_32x32x16_bf16 v[48:63], v[88:91], v[136:139], v[48:63]
    ds_read_b64_tr_b16 v[88:89], v192 offset:16384
    ds_read_b64_tr_b16 v[90:91], v192 offset:17408
    buffer_load_dwordx4 v[120:123], v178, s[56:59], s11 offen
    s_waitcnt lgkmcnt(15)
    v_mfma_f32_32x32x16_bf16 v[64:79], v[92:95], v[136:139], v[64:79]
    ds_read_b64_tr_b16 v[92:93], v193 offset:16384
    ds_read_b64_tr_b16 v[94:95], v193 offset:17408
    v_mfma_f32_32x32x16_bf16 v[16:31], v[96:99], v[140:143], v[16:31]
    ds_read_b64_tr_b16 v[96:97], v190 offset:20480
    ds_read_b64_tr_b16 v[98:99], v190 offset:21504
    ds_read_b128 v[152:155], v188
    s_waitcnt lgkmcnt(15)
    v_mfma_f32_32x32x16_bf16 v[32:47], v[100:103], v[140:143], v[32:47]
    ds_read_b64_tr_b16 v[100:101], v191 offset:20480
    ds_read_b64_tr_b16 v[102:103], v191 offset:21504
    ds_read_b128 v[156:159], v189
    s_add_u32 m0, s10, 50176
    s_nop 0
    buffer_load_dwordx4 v181, s[60:63], s78 offen lds
    v_mfma_f32_32x32x16_bf16 v[48:63], v[104:107], v[140:143], v[48:63]
    ds_read_b64_tr_b16 v[104:105], v192 offset:20480
    ds_read_b64_tr_b16 v[106:107], v192 offset:21504
    buffer_load_dwordx4 v[124:127], v179, s[56:59], s11 offen
    s_waitcnt lgkmcnt(15)
    v_mfma_f32_32x32x16_bf16 v[64:79], v[108:111], v[140:143], v[64:79]
    ds_read_b64_tr_b16 v[108:109], v193 offset:20480
    ds_read_b64_tr_b16 v[110:111], v193 offset:21504
    v_mfma_f32_32x32x16_bf16 v[16:31], v[80:83], v[144:147], v[16:31]
    ds_read_b64_tr_b16 v[80:81], v190 offset:24576
    ds_read_b64_tr_b16 v[82:83], v190 offset:25600
    s_waitcnt vmcnt(12)
    ds_write_b128 v184, v[160:163] offset:0
    s_waitcnt lgkmcnt(15)
    v_mfma_f32_32x32x16_bf16 v[32:47], v[84:87], v[144:147], v[32:47]
    ds_read_b64_tr_b16 v[84:85], v191 offset:24576
    ds_read_b64_tr_b16 v[86:87], v191 offset:25600
    s_waitcnt vmcnt(11)
    ds_write_b128 v185, v[164:167] offset:1024
    s_add_u32 m0, s10, 51200
    s_nop 0
    buffer_load_dwordx4 v182, s[60:63], s78 offen lds
    v_mfma_f32_32x32x16_bf16 v[48:63], v[88:91], v[144:147], v[48:63]
    ds_read_b64_tr_b16 v[88:89], v192 offset:24576
    ds_read_b64_tr_b16 v[90:91], v192 offset:25600
    s_lshl_b32 s11, s21, 7
    buffer_load_dwordx4 v[128:131], v176, s[56:59], s11 offen
    s_waitcnt lgkmcnt(15)
    v_mfma_f32_32x32x16_bf16 v[64:79], v[92:95], v[144:147], v[64:79]
    ds_read_b64_tr_b16 v[92:93], v193 offset:24576
    ds_read_b64_tr_b16 v[94:95], v193 offset:25600
    v_mfma_f32_32x32x16_bf16 v[16:31], v[96:99], v[148:151], v[16:31]
    ds_read_b64_tr_b16 v[96:97], v190 offset:28672
    ds_read_b64_tr_b16 v[98:99], v190 offset:29696
    s_waitcnt vmcnt(11)
    ds_write_b128 v184, v[168:171] offset:2048
    s_waitcnt lgkmcnt(15)
    v_mfma_f32_32x32x16_bf16 v[32:47], v[100:103], v[148:151], v[32:47]
    ds_read_b64_tr_b16 v[100:101], v191 offset:28672
    ds_read_b64_tr_b16 v[102:103], v191 offset:29696
    s_waitcnt vmcnt(10)
    ds_write_b128 v185, v[172:175] offset:3072
    s_add_u32 m0, s10, 52224
    s_nop 0
    buffer_load_dwordx4 v183, s[60:63], s78 offen lds
    v_mfma_f32_32x32x16_bf16 v[48:63], v[104:107], v[148:151], v[48:63]
    ds_read_b64_tr_b16 v[104:105], v192 offset:28672
    ds_read_b64_tr_b16 v[106:107], v192 offset:29696
    buffer_load_dwordx4 v[132:135], v177, s[56:59], s11 offen
    s_waitcnt lgkmcnt(15)
    v_mfma_f32_32x32x16_bf16 v[64:79], v[108:111], v[148:151], v[64:79]
    ds_read_b64_tr_b16 v[108:109], v193 offset:28672
    ds_read_b64_tr_b16 v[110:111], v193 offset:29696
    v_and_b32 v197, 31, v2
    v_mul_u32_u24 v197, 336, v197
    s_mul_i32 s68, s3, 10752
    s_add_u32 s68, s68, 32768
    v_add_u32 v197, s68, v197
    v_mul_u32_u24 v195, 48, v11
    v_add_u32 v195, v195, v197
    v_lshl_add_u32 v196, v11, 3, v197
    v_mov_b32 v208, 0x3f803f80
    v_mov_b32 v209, 0x3f803f80
    s_waitcnt vmcnt(9)
    s_barrier
    v_mfma_f32_32x32x16_bf16 v[16:31], v[80:83], v[152:155], v[16:31]
    ds_read_b64_tr_b16 v[80:81], v190 offset:32768
    ds_read_b64_tr_b16 v[82:83], v190 offset:33792
    ds_read_b128 v[160:163], v186
    s_waitcnt lgkmcnt(15)
    v_mfma_f32_32x32x16_bf16 v[32:47], v[84:87], v[152:155], v[32:47]
    ds_read_b64_tr_b16 v[84:85], v191 offset:32768
    ds_read_b64_tr_b16 v[86:87], v191 offset:33792
    ds_read_b128 v[164:167], v187
    s_mul_i32 s78, s21, 245760
    s_add_u32 m0, s10, 0
    s_nop 0
    buffer_load_dwordx4 v180, s[60:63], s78 offen lds
    v_mfma_f32_32x32x16_bf16 v[48:63], v[88:91], v[152:155], v[48:63]
    ds_read_b64_tr_b16 v[88:89], v192 offset:32768
    ds_read_b64_tr_b16 v[90:91], v192 offset:33792
    buffer_load_dwordx4 v[136:139], v178, s[56:59], s11 offen
    s_waitcnt lgkmcnt(15)
    v_mfma_f32_32x32x16_bf16 v[64:79], v[92:95], v[152:155], v[64:79]
    ds_read_b64_tr_b16 v[92:93], v193 offset:32768
    ds_read_b64_tr_b16 v[94:95], v193 offset:33792
    v_mfma_f32_32x32x16_bf16 v[16:31], v[96:99], v[156:159], v[16:31]
    ds_read_b64_tr_b16 v[96:97], v190 offset:36864
    ds_read_b64_tr_b16 v[98:99], v190 offset:37888
    ds_read_b128 v[168:171], v188
    s_waitcnt lgkmcnt(15)
    v_mfma_f32_32x32x16_bf16 v[32:47], v[100:103], v[156:159], v[32:47]
    ds_read_b64_tr_b16 v[100:101], v191 offset:36864
    ds_read_b64_tr_b16 v[102:103], v191 offset:37888
    ds_read_b128 v[172:175], v189
    s_add_u32 m0, s10, 1024
    s_nop 0
    buffer_load_dwordx4 v181, s[60:63], s78 offen lds
    v_mfma_f32_32x32x16_bf16 v[48:63], v[104:107], v[156:159], v[48:63]
    ds_read_b64_tr_b16 v[104:105], v192 offset:36864
    ds_read_b64_tr_b16 v[106:107], v192 offset:37888
    buffer_load_dwordx4 v[140:143], v179, s[56:59], s11 offen
    s_waitcnt lgkmcnt(15)
    v_mfma_f32_32x32x16_bf16 v[64:79], v[108:111], v[156:159], v[64:79]
    ds_read_b64_tr_b16 v[108:109], v193 offset:36864
    ds_read_b64_tr_b16 v[110:111], v193 offset:37888
    v_mfma_f32_32x32x16_bf16 v[16:31], v[80:83], v[160:163], v[16:31]
    ds_read_b64_tr_b16 v[80:81], v190 offset:40960
    ds_read_b64_tr_b16 v[82:83], v190 offset:41984
    ds_write_b128 v184, v[112:115] offset:0
    s_waitcnt lgkmcnt(15)
    v_mfma_f32_32x32x16_bf16 v[32:47], v[84:87], v[160:163], v[32:47]
    ds_read_b64_tr_b16 v[84:85], v191 offset:40960
    ds_read_b64_tr_b16 v[86:87], v191 offset:41984
    s_waitcnt vmcnt(12)
    ds_write_b128 v185, v[116:119] offset:1024
    s_add_u32 m0, s10, 2048
    s_nop 0
    buffer_load_dwordx4 v182, s[60:63], s78 offen lds
    v_mfma_f32_32x32x16_bf16 v[48:63], v[88:91], v[160:163], v[48:63]
    ds_read_b64_tr_b16 v[88:89], v192 offset:40960
    ds_read_b64_tr_b16 v[90:91], v192 offset:41984
    s_lshl_b32 s11, s22, 7
    buffer_load_dwordx4 v[144:147], v176, s[56:59], s11 offen
    s_waitcnt lgkmcnt(15)
    v_mfma_f32_32x32x16_bf16 v[64:79], v[92:95], v[160:163], v[64:79]
    ds_read_b64_tr_b16 v[92:93], v193 offset:40960
    ds_read_b64_tr_b16 v[94:95], v193 offset:41984
    v_mfma_f32_32x32x16_bf16 v[16:31], v[96:99], v[164:167], v[16:31]
    ds_read_b64_tr_b16 v[96:97], v190 offset:45056
    ds_read_b64_tr_b16 v[98:99], v190 offset:46080
    s_waitcnt vmcnt(12)
    ds_write_b128 v184, v[120:123] offset:2048
    s_waitcnt lgkmcnt(15)
    v_mfma_f32_32x32x16_bf16 v[32:47], v[100:103], v[164:167], v[32:47]
    ds_read_b64_tr_b16 v[100:101], v191 offset:45056
    ds_read_b64_tr_b16 v[102:103], v191 offset:46080
    s_waitcnt vmcnt(10)
    ds_write_b128 v185, v[124:127] offset:3072
    s_add_u32 m0, s10, 3072
    s_nop 0
    buffer_load_dwordx4 v183, s[60:63], s78 offen lds
    v_mfma_f32_32x32x16_bf16 v[48:63], v[104:107], v[164:167], v[48:63]
    ds_read_b64_tr_b16 v[104:105], v192 offset:45056
    ds_read_b64_tr_b16 v[106:107], v192 offset:46080
    buffer_load_dwordx4 v[148:151], v177, s[56:59], s11 offen
    s_waitcnt lgkmcnt(15)
    v_mfma_f32_32x32x16_bf16 v[64:79], v[108:111], v[164:167], v[64:79]
    ds_read_b64_tr_b16 v[108:109], v193 offset:45056
    ds_read_b64_tr_b16 v[110:111], v193 offset:46080
    v_mul_u32_u24 v3, 336, v12
    s_mul_i32 s68, s3, 48
    s_add_u32 s68, s68, 32768
    v_min_u32 v4, 4, v13
    v_lshl_add_u32 v198, v4, 3, v3
    v_add_u32 v198, s68, v198
    s_lshr_b32 s68, s3, 1
    s_mul_i32 s68, s68, 40
    s_add_u32 s68, s68, 192
    v_lshl_add_u32 v199, v13, 3, s68
    v_cmp_gt_u32 vcc, 5, v13
    v_mov_b32 v4, 272
    s_nop 0
    v_cndmask_b32 v199, v4, v199, vcc
    v_add_u32 v199, 32768, v199
    v_add_u32 v199, v199, v3
    s_waitcnt vmcnt(9)
    s_barrier
    v_mfma_f32_32x32x16_bf16 v[16:31], v[80:83], v[168:171], v[16:31]
    ds_read_b64_tr_b16 v[80:81], v190 offset:49152
    ds_read_b64_tr_b16 v[82:83], v190 offset:50176
    ds_read_b128 v[112:115], v186
    s_waitcnt lgkmcnt(15)
    v_mfma_f32_32x32x16_bf16 v[32:47], v[84:87], v[168:171], v[32:47]
    ds_read_b64_tr_b16 v[84:85], v191 offset:49152
    ds_read_b64_tr_b16 v[86:87], v191 offset:50176
    ds_read_b128 v[116:119], v187
    s_mul_i32 s78, s22, 245760
    s_add_u32 m0, s10, 16384
    s_nop 0
    buffer_load_dwordx4 v180, s[60:63], s78 offen lds
    v_mfma_f32_32x32x16_bf16 v[48:63], v[88:91], v[168:171], v[48:63]
    ds_read_b64_tr_b16 v[88:89], v192 offset:49152
    ds_read_b64_tr_b16 v[90:91], v192 offset:50176
    buffer_load_dwordx4 v[152:155], v178, s[56:59], s11 offen
    s_waitcnt lgkmcnt(15)
    v_mfma_f32_32x32x16_bf16 v[64:79], v[92:95], v[168:171], v[64:79]
    ds_read_b64_tr_b16 v[92:93], v193 offset:49152
    ds_read_b64_tr_b16 v[94:95], v193 offset:50176
    v_mfma_f32_32x32x16_bf16 v[16:31], v[96:99], v[172:175], v[16:31]
    ds_read_b64_tr_b16 v[96:97], v190 offset:53248
    ds_read_b64_tr_b16 v[98:99], v190 offset:54272
    ds_read_b128 v[120:123], v188
    s_waitcnt lgkmcnt(15)
    v_mfma_f32_32x32x16_bf16 v[32:47], v[100:103], v[172:175], v[32:47]
    ds_read_b64_tr_b16 v[100:101], v191 offset:53248
    ds_read_b64_tr_b16 v[102:103], v191 offset:54272
    ds_read_b128 v[124:127], v189
    s_add_u32 m0, s10, 17408
    s_nop 0
    buffer_load_dwordx4 v181, s[60:63], s78 offen lds
    v_mfma_f32_32x32x16_bf16 v[48:63], v[104:107], v[172:175], v[48:63]
    ds_read_b64_tr_b16 v[104:105], v192 offset:53248
    ds_read_b64_tr_b16 v[106:107], v192 offset:54272
    buffer_load_dwordx4 v[156:159], v179, s[56:59], s11 offen
    s_waitcnt lgkmcnt(15)
    v_mfma_f32_32x32x16_bf16 v[64:79], v[108:111], v[172:175], v[64:79]
    ds_read_b64_tr_b16 v[108:109], v193 offset:53248
    ds_read_b64_tr_b16 v[110:111], v193 offset:54272
    s_load_dwordx2 s[36:37], s[0:1], 0
    s_lshr_b32 s33, s2, 3
    s_lshl_b32 s33, s33, 6
    s_lshl_b32 s68, s3, 4
    s_add_u32 s33, s33, s68
    v_bfe_u32 v3, v2, 1, 4
    v_add_u32 v3, s33, v3
    v_mul_u32_u24 v3, 1280, v3
    v_and_b32 v4, 1, v2
    v_mul_u32_u24 v4, 156, v4
    s_and_b32 s33, s2, 7
    s_mul_i32 s33, s33, 160
    v_add3_u32 v3, v3, v4, s33
    s_mov_b32 exec_hi, 0
    s_waitcnt lgkmcnt(0)
    global_load_dword v233, v3, s[36:37]
    s_mov_b32 exec_hi, -1
    v_mfma_f32_32x32x16_bf16 v[16:31], v[80:83], v[112:115], v[16:31]
    ds_read_b64_tr_b16 v[80:81], v190 offset:57344
    ds_read_b64_tr_b16 v[82:83], v190 offset:58368
    ds_write_b128 v184, v[128:131] offset:0
    v_mfma_f32_32x32x16_bf16 v[32:47], v[84:87], v[112:115], v[32:47]
    ds_read_b64_tr_b16 v[84:85], v191 offset:57344
    ds_read_b64_tr_b16 v[86:87], v191 offset:58368
    s_waitcnt vmcnt(13)
    ds_write_b128 v185, v[132:135] offset:1024
    s_add_u32 m0, s10, 18432
    s_nop 0
    buffer_load_dwordx4 v182, s[60:63], s78 offen lds
    v_mfma_f32_32x32x16_bf16 v[48:63], v[88:91], v[112:115], v[48:63]
    ds_read_b64_tr_b16 v[88:89], v192 offset:57344
    ds_read_b64_tr_b16 v[90:91], v192 offset:58368
    s_lshl_b32 s11, s23, 7
    buffer_load_dwordx4 v[160:163], v176, s[56:59], s11 offen
    v_mfma_f32_32x32x16_bf16 v[64:79], v[92:95], v[112:115], v[64:79]
    ds_read_b64_tr_b16 v[92:93], v193 offset:57344
    ds_read_b64_tr_b16 v[94:95], v193 offset:58368
    v_mfma_f32_32x32x16_bf16 v[16:31], v[96:99], v[116:119], v[16:31]
    ds_read_b64_tr_b16 v[96:97], v190 offset:61440
    ds_read_b64_tr_b16 v[98:99], v190 offset:62464
    s_waitcnt vmcnt(13)
    ds_write_b128 v184, v[136:139] offset:2048
    v_mfma_f32_32x32x16_bf16 v[32:47], v[100:103], v[116:119], v[32:47]
    ds_read_b64_tr_b16 v[100:101], v191 offset:61440
    ds_read_b64_tr_b16 v[102:103], v191 offset:62464
    s_waitcnt vmcnt(11)
    ds_write_b128 v185, v[140:143] offset:3072
    s_add_u32 m0, s10, 19456
    s_nop 0
    buffer_load_dwordx4 v183, s[60:63], s78 offen lds
    v_mfma_f32_32x32x16_bf16 v[48:63], v[104:107], v[116:119], v[48:63]
    ds_read_b64_tr_b16 v[104:105], v192 offset:61440
    ds_read_b64_tr_b16 v[106:107], v192 offset:62464
    buffer_load_dwordx4 v[164:167], v177, s[56:59], s11 offen
    v_mfma_f32_32x32x16_bf16 v[64:79], v[108:111], v[116:119], v[64:79]
    ds_read_b64_tr_b16 v[108:109], v193 offset:61440
    ds_read_b64_tr_b16 v[110:111], v193 offset:62464
    v_and_b32 v3, 7, v2
    s_lshr_b32 s68, s9, 1
    v_lshl_add_u32 v4, s68, 3, v3
    v_and_b32 v3, 3, v2
    s_add_u32 s68, s68, 160
    v_lshl_add_u32 v3, v3, 3, s68
    v_cndmask_b32 v4, v4, v3, s[14:15]
    v_lshlrev_b32 v4, 7, v4
    v_add_u32 v201, 282624, v4
    v_and_b32 v3, 15, v2
    s_lshl_b32 s68, s32, 13
    s_lshl_b32 s69, s3, 7
    s_add_u32 s69, s69, 393216
    s_add_u32 s68, s68, s69
    v_lshl_add_u32 v203, v3, 9, s68
    s_lshl_b32 s68, s9, 13
    s_add_u32 s77, s68, s69
    s_lshl_b32 s68, s8, 9
    s_add_u32 s77, s77, s68
    s_lshl_b32 s69, s3, 15
    s_add_u32 s68, s68, s69
    s_and_b32 s69, s9, 1
    s_lshl_b32 s69, s69, 8
    s_add_u32 s68, s68, s69
    s_add_u32 s68, s68, 393216
    v_and_b32 v4, 3, v2
    v_lshl_add_u32 v4, v4, 13, s68
    v_bfe_u32 v5, v2, 2, 1
    v_lshl_add_u32 v210, v5, 7, v4
    s_waitcnt vmcnt(10)
    s_barrier
    s_waitcnt lgkmcnt(15)
    v_mfma_f32_32x32x16_bf16 v[16:31], v[80:83], v[120:123], v[16:31]
    ds_read_b64_tr_b16 v[80:81], v190 offset:0
    ds_read_b64_tr_b16 v[82:83], v190 offset:1024
    ds_read_b128 v[128:131], v186
    v_mfma_f32_32x32x16_bf16 v[32:47], v[84:87], v[120:123], v[32:47]
    ds_read_b64_tr_b16 v[84:85], v191 offset:0
    ds_read_b64_tr_b16 v[86:87], v191 offset:1024
    ds_read_b128 v[132:135], v187
    s_mul_i32 s78, s23, 245760
    s_add_u32 m0, s10, 32768
    s_nop 0
    buffer_load_dwordx4 v180, s[60:63], s78 offen lds
    s_waitcnt lgkmcnt(15)
    v_mfma_f32_32x32x16_bf16 v[48:63], v[88:91], v[120:123], v[48:63]
    ds_read_b64_tr_b16 v[88:89], v192 offset:0
    ds_read_b64_tr_b16 v[90:91], v192 offset:1024
    buffer_load_dwordx4 v[168:171], v178, s[56:59], s11 offen
    v_mfma_f32_32x32x16_bf16 v[64:79], v[92:95], v[120:123], v[64:79]
    ds_read_b64_tr_b16 v[92:93], v193 offset:0
    ds_read_b64_tr_b16 v[94:95], v193 offset:1024
    s_waitcnt lgkmcnt(15)
    v_mfma_f32_32x32x16_bf16 v[16:31], v[96:99], v[124:127], v[16:31]
    ds_read_b64_tr_b16 v[96:97], v190 offset:4096
    ds_read_b64_tr_b16 v[98:99], v190 offset:5120
    ds_read_b128 v[136:139], v188
    v_mfma_f32_32x32x16_bf16 v[32:47], v[100:103], v[124:127], v[32:47]
    ds_read_b64_tr_b16 v[100:101], v191 offset:4096
    ds_read_b64_tr_b16 v[102:103], v191 offset:5120
    ds_read_b128 v[140:143], v189
    s_add_u32 m0, s10, 33792
    s_nop 0
    buffer_load_dwordx4 v181, s[60:63], s78 offen lds
    s_waitcnt lgkmcnt(15)
    v_mfma_f32_32x32x16_bf16 v[48:63], v[104:107], v[124:127], v[48:63]
    ds_read_b64_tr_b16 v[104:105], v192 offset:4096
    ds_read_b64_tr_b16 v[106:107], v192 offset:5120
    buffer_load_dwordx4 v[172:175], v179, s[56:59], s11 offen
    v_mfma_f32_32x32x16_bf16 v[64:79], v[108:111], v[124:127], v[64:79]
    ds_read_b64_tr_b16 v[108:109], v193 offset:4096
    ds_read_b64_tr_b16 v[110:111], v193 offset:5120
    s_waitcnt lgkmcnt(15)
    v_mfma_f32_32x32x16_bf16 v[16:31], v[80:83], v[128:131], v[16:31]
    ds_read_b64_tr_b16 v[80:81], v190 offset:8192
    ds_read_b64_tr_b16 v[82:83], v190 offset:9216
    ds_write_b128 v184, v[144:147] offset:0
    v_mfma_f32_32x32x16_bf16 v[32:47], v[84:87], v[128:131], v[32:47]
    ds_read_b64_tr_b16 v[84:85], v191 offset:8192
    ds_read_b64_tr_b16 v[86:87], v191 offset:9216
    s_waitcnt vmcnt(13)
    ds_write_b128 v185, v[148:151] offset:1024
    s_add_u32 m0, s10, 34816
    s_nop 0
    buffer_load_dwordx4 v182, s[60:63], s78 offen lds
    s_waitcnt lgkmcnt(15)
    v_mfma_f32_32x32x16_bf16 v[48:63], v[88:91], v[128:131], v[48:63]
    ds_read_b64_tr_b16 v[88:89], v192 offset:8192
    ds_read_b64_tr_b16 v[90:91], v192 offset:9216
    s_lshl_b32 s11, s24, 7
    buffer_load_dwordx4 v[112:115], v176, s[56:59], s11 offen
    v_mfma_f32_32x32x16_bf16 v[64:79], v[92:95], v[128:131], v[64:79]
    ds_read_b64_tr_b16 v[92:93], v193 offset:8192
    ds_read_b64_tr_b16 v[94:95], v193 offset:9216
    s_waitcnt lgkmcnt(15)
    v_mfma_f32_32x32x16_bf16 v[16:31], v[96:99], v[132:135], v[16:31]
    ds_read_b64_tr_b16 v[96:97], v190 offset:12288
    ds_read_b64_tr_b16 v[98:99], v190 offset:13312
    s_waitcnt vmcnt(13)
    ds_write_b128 v184, v[152:155] offset:2048
    v_mfma_f32_32x32x16_bf16 v[32:47], v[100:103], v[132:135], v[32:47]
    ds_read_b64_tr_b16 v[100:101], v191 offset:12288
    ds_read_b64_tr_b16 v[102:103], v191 offset:13312
    s_waitcnt vmcnt(11)
    ds_write_b128 v185, v[156:159] offset:3072
    s_add_u32 m0, s10, 35840
    s_nop 0
    buffer_load_dwordx4 v183, s[60:63], s78 offen lds
    s_waitcnt lgkmcnt(15)
    v_mfma_f32_32x32x16_bf16 v[48:63], v[104:107], v[132:135], v[48:63]
    ds_read_b64_tr_b16 v[104:105], v192 offset:12288
    ds_read_b64_tr_b16 v[106:107], v192 offset:13312
    buffer_load_dwordx4 v[116:119], v177, s[56:59], s11 offen
    v_mfma_f32_32x32x16_bf16 v[64:79], v[108:111], v[132:135], v[64:79]
    ds_read_b64_tr_b16 v[108:109], v193 offset:12288
    ds_read_b64_tr_b16 v[110:111], v193 offset:13312
    s_lshr_b32 s68, s3, 1
    s_mul_i32 s68, s68, 1680
    s_and_b32 s69, s3, 1
    s_mul_i32 s69, s69, 40
    s_add_u32 s68, s68, s69
    v_and_b32 v3, 31, v2
    v_mul_u32_u24 v3, 80, v3
    v_lshl_add_u32 v3, v11, 3, v3
    v_add_u32 v202, s68, v3
    v_and_b32 v3, 3, v2
    v_bfe_u32 v4, v2, 3, 2
    v_lshl_add_u32 v3, v4, 2, v3
    v_bfe_u32 v4, v2, 2, 1
    v_mul_u32_u24 v4, 10, v4
    v_add_u32 v4, v4, v3
    v_cmp_gt_u32 vcc, 10, v3
    v_mov_b32 v5, 20
    s_nop 0
    v_cndmask_b32 v4, v5, v4, vcc
    v_mul_u32_u24 v4, 80, v4
    v_mul_u32_u24 v5, 40, v11
    v_add_u32 v204, v4, v5
    buffer_load_dword v14, v15, s[52:55], 0 offen sc1
    s_waitcnt vmcnt(10)
    s_barrier
    s_waitcnt lgkmcnt(15)
    v_mfma_f32_32x32x16_bf16 v[16:31], v[80:83], v[136:139], v[16:31]
    ds_read_b64_tr_b16 v[80:81], v190 offset:16384
    ds_read_b64_tr_b16 v[82:83], v190 offset:17408
    ds_read_b128 v[144:147], v186
    v_mfma_f32_32x32x16_bf16 v[32:47], v[84:87], v[136:139], v[32:47]
    ds_read_b64_tr_b16 v[84:85], v191 offset:16384
    ds_read_b64_tr_b16 v[86:87], v191 offset:17408
    ds_read_b128 v[148:151], v187
    s_mul_i32 s78, s24, 245760
    s_add_u32 m0, s10, 49152
    s_nop 0
    buffer_load_dwordx4 v180, s[60:63], s78 offen lds
    s_waitcnt lgkmcnt(15)
    v_mfma_f32_32x32x16_bf16 v[48:63], v[88:91], v[136:139], v[48:63]
    ds_read_b64_tr_b16 v[88:89], v192 offset:16384
    ds_read_b64_tr_b16 v[90:91], v192 offset:17408
    buffer_load_dwordx4 v[120:123], v178, s[56:59], s11 offen
    v_mfma_f32_32x32x16_bf16 v[64:79], v[92:95], v[136:139], v[64:79]
    ds_read_b64_tr_b16 v[92:93], v193 offset:16384
    ds_read_b64_tr_b16 v[94:95], v193 offset:17408
    s_waitcnt lgkmcnt(15)
    v_mfma_f32_32x32x16_bf16 v[16:31], v[96:99], v[140:143], v[16:31]
    ds_read_b64_tr_b16 v[96:97], v190 offset:20480
    ds_read_b64_tr_b16 v[98:99], v190 offset:21504
    ds_read_b128 v[152:155], v188
    v_mfma_f32_32x32x16_bf16 v[32:47], v[100:103], v[140:143], v[32:47]
    ds_read_b64_tr_b16 v[100:101], v191 offset:20480
    ds_read_b64_tr_b16 v[102:103], v191 offset:21504
    ds_read_b128 v[156:159], v189
    s_add_u32 m0, s10, 50176
    s_nop 0
    buffer_load_dwordx4 v181, s[60:63], s78 offen lds
    s_waitcnt lgkmcnt(15)
    v_mfma_f32_32x32x16_bf16 v[48:63], v[104:107], v[140:143], v[48:63]
    ds_read_b64_tr_b16 v[104:105], v192 offset:20480
    ds_read_b64_tr_b16 v[106:107], v192 offset:21504
    buffer_load_dwordx4 v[124:127], v179, s[56:59], s11 offen
    v_mfma_f32_32x32x16_bf16 v[64:79], v[108:111], v[140:143], v[64:79]
    ds_read_b64_tr_b16 v[108:109], v193 offset:20480
    ds_read_b64_tr_b16 v[110:111], v193 offset:21504
    s_waitcnt lgkmcnt(15)
    v_mfma_f32_32x32x16_bf16 v[16:31], v[80:83], v[144:147], v[16:31]
    ds_read_b64_tr_b16 v[80:81], v190 offset:24576
    ds_read_b64_tr_b16 v[82:83], v190 offset:25600
    ds_write_b128 v184, v[160:163] offset:0
    v_mfma_f32_32x32x16_bf16 v[32:47], v[84:87], v[144:147], v[32:47]
    ds_read_b64_tr_b16 v[84:85], v191 offset:24576
    ds_read_b64_tr_b16 v[86:87], v191 offset:25600
    s_waitcnt vmcnt(13)
    ds_write_b128 v185, v[164:167] offset:1024
    s_add_u32 m0, s10, 51200
    s_nop 0
    buffer_load_dwordx4 v182, s[60:63], s78 offen lds
    s_waitcnt lgkmcnt(15)
    v_mfma_f32_32x32x16_bf16 v[48:63], v[88:91], v[144:147], v[48:63]
    ds_read_b64_tr_b16 v[88:89], v192 offset:24576
    ds_read_b64_tr_b16 v[90:91], v192 offset:25600
    s_lshl_b32 s11, s25, 7
    buffer_load_dwordx4 v[128:131], v176, s[56:59], s11 offen
    v_mfma_f32_32x32x16_bf16 v[64:79], v[92:95], v[144:147], v[64:79]
    ds_read_b64_tr_b16 v[92:93], v193 offset:24576
    ds_read_b64_tr_b16 v[94:95], v193 offset:25600
    s_waitcnt lgkmcnt(15)
    v_mfma_f32_32x32x16_bf16 v[16:31], v[96:99], v[148:151], v[16:31]
    ds_read_b64_tr_b16 v[96:97], v190 offset:28672
    ds_read_b64_tr_b16 v[98:99], v190 offset:29696
    s_waitcnt vmcnt(13)
    ds_write_b128 v184, v[168:171] offset:2048
    v_mfma_f32_32x32x16_bf16 v[32:47], v[100:103], v[148:151], v[32:47]
    ds_read_b64_tr_b16 v[100:101], v191 offset:28672
    ds_read_b64_tr_b16 v[102:103], v191 offset:29696
    s_waitcnt vmcnt(11)
    ds_write_b128 v185, v[172:175] offset:3072
    s_add_u32 m0, s10, 52224
    s_nop 0
    buffer_load_dwordx4 v183, s[60:63], s78 offen lds
    s_waitcnt lgkmcnt(15)
    v_mfma_f32_32x32x16_bf16 v[48:63], v[104:107], v[148:151], v[48:63]
    ds_read_b64_tr_b16 v[104:105], v192 offset:28672
    ds_read_b64_tr_b16 v[106:107], v192 offset:29696
    buffer_load_dwordx4 v[132:135], v177, s[56:59], s11 offen
    v_mfma_f32_32x32x16_bf16 v[64:79], v[108:111], v[148:151], v[64:79]
    ds_read_b64_tr_b16 v[108:109], v193 offset:28672
    ds_read_b64_tr_b16 v[110:111], v193 offset:29696
    s_mov_b32 s28, s38
    s_and_b32 s29, s39, 0xffff
    s_mov_b32 s30, 25600
    s_mov_b32 s31, 0x20000
    v_bfe_u32 v3, v2, 2, 2
    v_lshl_add_u32 v3, v11, 2, v3
    v_min_u32 v4, 4, v13
    v_mul_u32_u24 v194, 40, v3
    v_lshl_add_u32 v194, v4, 3, v194
    s_and_b32 s68, s32, 1
    s_mul_i32 s68, s68, 1600
    v_add_u32 v207, s68, v194
    s_and_b32 s68, s9, 1
    s_mul_i32 s68, s68, 1600
    v_add_u32 v194, s68, v194
    s_waitcnt vmcnt(10)
    s_barrier
    s_waitcnt lgkmcnt(15)
    v_mfma_f32_32x32x16_bf16 v[16:31], v[80:83], v[152:155], v[16:31]
    ds_read_b64_tr_b16 v[80:81], v190 offset:32768
    ds_read_b64_tr_b16 v[82:83], v190 offset:33792
    ds_read_b128 v[160:163], v186
    v_mfma_f32_32x32x16_bf16 v[32:47], v[84:87], v[152:155], v[32:47]
    ds_read_b64_tr_b16 v[84:85], v191 offset:32768
    ds_read_b64_tr_b16 v[86:87], v191 offset:33792
    ds_read_b128 v[164:167], v187
    s_mul_i32 s78, s25, 245760
    s_add_u32 m0, s10, 0
    s_nop 0
    buffer_load_dwordx4 v180, s[60:63], s78 offen lds
    s_waitcnt lgkmcnt(15)
    v_mfma_f32_32x32x16_bf16 v[48:63], v[88:91], v[152:155], v[48:63]
    ds_read_b64_tr_b16 v[88:89], v192 offset:32768
    ds_read_b64_tr_b16 v[90:91], v192 offset:33792
    buffer_load_dwordx4 v[136:139], v178, s[56:59], s11 offen
    v_mfma_f32_32x32x16_bf16 v[64:79], v[92:95], v[152:155], v[64:79]
    ds_read_b64_tr_b16 v[92:93], v193 offset:32768
    ds_read_b64_tr_b16 v[94:95], v193 offset:33792
    s_waitcnt lgkmcnt(15)
    v_mfma_f32_32x32x16_bf16 v[16:31], v[96:99], v[156:159], v[16:31]
    ds_read_b64_tr_b16 v[96:97], v190 offset:36864
    ds_read_b64_tr_b16 v[98:99], v190 offset:37888
    ds_read_b128 v[168:171], v188
    v_mfma_f32_32x32x16_bf16 v[32:47], v[100:103], v[156:159], v[32:47]
    ds_read_b64_tr_b16 v[100:101], v191 offset:36864
    ds_read_b64_tr_b16 v[102:103], v191 offset:37888
    ds_read_b128 v[172:175], v189
    s_add_u32 m0, s10, 1024
    s_nop 0
    buffer_load_dwordx4 v181, s[60:63], s78 offen lds
    s_waitcnt lgkmcnt(15)
    v_mfma_f32_32x32x16_bf16 v[48:63], v[104:107], v[156:159], v[48:63]
    ds_read_b64_tr_b16 v[104:105], v192 offset:36864
    ds_read_b64_tr_b16 v[106:107], v192 offset:37888
    buffer_load_dwordx4 v[140:143], v179, s[56:59], s11 offen
    v_mfma_f32_32x32x16_bf16 v[64:79], v[108:111], v[156:159], v[64:79]
    ds_read_b64_tr_b16 v[108:109], v193 offset:36864
    ds_read_b64_tr_b16 v[110:111], v193 offset:37888
    s_waitcnt lgkmcnt(15)
    v_mfma_f32_32x32x16_bf16 v[16:31], v[80:83], v[160:163], v[16:31]
    ds_read_b64_tr_b16 v[80:81], v190 offset:40960
    ds_read_b64_tr_b16 v[82:83], v190 offset:41984
    ds_write_b128 v184, v[112:115] offset:0
    v_mfma_f32_32x32x16_bf16 v[32:47], v[84:87], v[160:163], v[32:47]
    ds_read_b64_tr_b16 v[84:85], v191 offset:40960
    ds_read_b64_tr_b16 v[86:87], v191 offset:41984
    s_waitcnt vmcnt(13)
    ds_write_b128 v185, v[116:119] offset:1024
    s_add_u32 m0, s10, 2048
    s_nop 0
    buffer_load_dwordx4 v182, s[60:63], s78 offen lds
    s_waitcnt lgkmcnt(15)
    v_mfma_f32_32x32x16_bf16 v[48:63], v[88:91], v[160:163], v[48:63]
    ds_read_b64_tr_b16 v[88:89], v192 offset:40960
    ds_read_b64_tr_b16 v[90:91], v192 offset:41984
    v_mfma_f32_32x32x16_bf16 v[64:79], v[92:95], v[160:163], v[64:79]
    ds_read_b64_tr_b16 v[92:93], v193 offset:40960
    ds_read_b64_tr_b16 v[94:95], v193 offset:41984
    s_waitcnt lgkmcnt(15)
    v_mfma_f32_32x32x16_bf16 v[16:31], v[96:99], v[164:167], v[16:31]
    ds_read_b64_tr_b16 v[96:97], v190 offset:45056
    ds_read_b64_tr_b16 v[98:99], v190 offset:46080
    s_waitcnt vmcnt(11)
    ds_write_b128 v184, v[120:123] offset:2048
    v_mfma_f32_32x32x16_bf16 v[32:47], v[100:103], v[164:167], v[32:47]
    ds_read_b64_tr_b16 v[100:101], v191 offset:45056
    ds_read_b64_tr_b16 v[102:103], v191 offset:46080
    s_waitcnt vmcnt(9)
    ds_write_b128 v185, v[124:127] offset:3072
    s_add_u32 m0, s10, 3072
    s_nop 0
    buffer_load_dwordx4 v183, s[60:63], s78 offen lds
    s_waitcnt lgkmcnt(15)
    v_mfma_f32_32x32x16_bf16 v[48:63], v[104:107], v[164:167], v[48:63]
    ds_read_b64_tr_b16 v[104:105], v192 offset:45056
    ds_read_b64_tr_b16 v[106:107], v192 offset:46080
    v_mfma_f32_32x32x16_bf16 v[64:79], v[108:111], v[164:167], v[64:79]
    ds_read_b64_tr_b16 v[108:109], v193 offset:45056
    ds_read_b64_tr_b16 v[110:111], v193 offset:46080
    s_waitcnt vmcnt(7)
    s_barrier
    s_waitcnt lgkmcnt(15)
    v_mfma_f32_32x32x16_bf16 v[16:31], v[80:83], v[168:171], v[16:31]
    ds_read_b64_tr_b16 v[80:81], v190 offset:49152
    ds_read_b64_tr_b16 v[82:83], v190 offset:50176
    ds_read_b128 v[112:115], v186
    v_mfma_f32_32x32x16_bf16 v[32:47], v[84:87], v[168:171], v[32:47]
    ds_read_b64_tr_b16 v[84:85], v191 offset:49152
    ds_read_b64_tr_b16 v[86:87], v191 offset:50176
    ds_read_b128 v[116:119], v187
    v_lshlrev_b32 v3, 4, v0
    s_lshr_b32 s68, s9, 1
    s_mul_i32 s68, s68, 3200
    s_lshl_b32 s69, s3, 10
    s_add_u32 m0, s69, 16384
    s_nop 0
    buffer_load_dwordx4 v3, s[28:31], s68 offen lds
    s_waitcnt lgkmcnt(15)
    v_mfma_f32_32x32x16_bf16 v[48:63], v[88:91], v[168:171], v[48:63]
    ds_read_b64_tr_b16 v[88:89], v192 offset:49152
    ds_read_b64_tr_b16 v[90:91], v192 offset:50176
    v_mfma_f32_32x32x16_bf16 v[64:79], v[92:95], v[168:171], v[64:79]
    ds_read_b64_tr_b16 v[92:93], v193 offset:49152
    ds_read_b64_tr_b16 v[94:95], v193 offset:50176
    s_waitcnt lgkmcnt(15)
    v_mfma_f32_32x32x16_bf16 v[16:31], v[96:99], v[172:175], v[16:31]
    ds_read_b64_tr_b16 v[96:97], v190 offset:53248
    ds_read_b64_tr_b16 v[98:99], v190 offset:54272
    ds_read_b128 v[120:123], v188
    v_mfma_f32_32x32x16_bf16 v[32:47], v[100:103], v[172:175], v[32:47]
    ds_read_b64_tr_b16 v[100:101], v191 offset:53248
    ds_read_b64_tr_b16 v[102:103], v191 offset:54272
    ds_read_b128 v[124:127], v189
    s_waitcnt lgkmcnt(15)
    v_mfma_f32_32x32x16_bf16 v[48:63], v[104:107], v[172:175], v[48:63]
    ds_read_b64_tr_b16 v[104:105], v192 offset:53248
    ds_read_b64_tr_b16 v[106:107], v192 offset:54272
    v_mfma_f32_32x32x16_bf16 v[64:79], v[108:111], v[172:175], v[64:79]
    ds_read_b64_tr_b16 v[108:109], v193 offset:53248
    ds_read_b64_tr_b16 v[110:111], v193 offset:54272
    s_waitcnt lgkmcnt(15)
    v_mfma_f32_32x32x16_bf16 v[16:31], v[80:83], v[112:115], v[16:31]
    ds_read_b64_tr_b16 v[80:81], v190 offset:57344
    ds_read_b64_tr_b16 v[82:83], v190 offset:58368
    ds_write_b128 v184, v[128:131] offset:0
    v_mfma_f32_32x32x16_bf16 v[32:47], v[84:87], v[112:115], v[32:47]
    ds_read_b64_tr_b16 v[84:85], v191 offset:57344
    ds_read_b64_tr_b16 v[86:87], v191 offset:58368
    s_waitcnt vmcnt(7)
    ds_write_b128 v185, v[132:135] offset:1024
    s_waitcnt lgkmcnt(15)
    v_mfma_f32_32x32x16_bf16 v[48:63], v[88:91], v[112:115], v[48:63]
    ds_read_b64_tr_b16 v[88:89], v192 offset:57344
    ds_read_b64_tr_b16 v[90:91], v192 offset:58368
    v_mfma_f32_32x32x16_bf16 v[64:79], v[92:95], v[112:115], v[64:79]
    ds_read_b64_tr_b16 v[92:93], v193 offset:57344
    ds_read_b64_tr_b16 v[94:95], v193 offset:58368
    s_waitcnt lgkmcnt(15)
    v_mfma_f32_32x32x16_bf16 v[16:31], v[96:99], v[116:119], v[16:31]
    ds_read_b64_tr_b16 v[96:97], v190 offset:61440
    ds_read_b64_tr_b16 v[98:99], v190 offset:62464
    s_waitcnt vmcnt(5)
    ds_write_b128 v184, v[136:139] offset:2048
    v_mfma_f32_32x32x16_bf16 v[32:47], v[100:103], v[116:119], v[32:47]
    ds_read_b64_tr_b16 v[100:101], v191 offset:61440
    ds_read_b64_tr_b16 v[102:103], v191 offset:62464
    s_waitcnt vmcnt(3)
    ds_write_b128 v185, v[140:143] offset:3072
    s_waitcnt lgkmcnt(15)
    v_mfma_f32_32x32x16_bf16 v[48:63], v[104:107], v[116:119], v[48:63]
    ds_read_b64_tr_b16 v[104:105], v192 offset:61440
    ds_read_b64_tr_b16 v[106:107], v192 offset:62464
    v_mfma_f32_32x32x16_bf16 v[64:79], v[108:111], v[116:119], v[64:79]
    ds_read_b64_tr_b16 v[108:109], v193 offset:61440
    ds_read_b64_tr_b16 v[110:111], v193 offset:62464
    s_waitcnt vmcnt(1)
    s_barrier
    s_waitcnt lgkmcnt(15)
    v_mfma_f32_32x32x16_bf16 v[16:31], v[80:83], v[120:123], v[16:31]
    ds_read_b64_tr_b16 v[80:81], v190 offset:0
    ds_read_b64_tr_b16 v[82:83], v190 offset:1024
    ds_read_b128 v[128:131], v186
    v_mfma_f32_32x32x16_bf16 v[32:47], v[84:87], v[120:123], v[32:47]
    ds_read_b64_tr_b16 v[84:85], v191 offset:0
    ds_read_b64_tr_b16 v[86:87], v191 offset:1024
    ds_read_b128 v[132:135], v187
    v_readfirstlane_b32 s79, v14
    s_mov_b32 s68, 20000
L_non8:
    s_cmp_lg_u32 s79, 0
    s_cbranch_scc1 L_non8_done
    s_sleep 8
    buffer_load_dword v14, v15, s[52:55], 0 offen sc1
    s_waitcnt vmcnt(0)
    v_readfirstlane_b32 s79, v14
    s_sub_u32 s68, s68, 1
    s_cmp_lg_u32 s68, 0
    s_cbranch_scc1 L_non8
L_non8_done:
    s_lshl_b32 s68, s2, 7
    s_add_u32 s68, s68, 327680
    v_mov_b32 v14, s79
    s_mov_b64 exec, 1
    buffer_store_dword v14, v15, s[48:51], s68 offen sc1
    s_mov_b64 exec, -1
    s_waitcnt lgkmcnt(15)
    v_mfma_f32_32x32x16_bf16 v[48:63], v[88:91], v[120:123], v[48:63]
    ds_read_b64_tr_b16 v[88:89], v192 offset:0
    ds_read_b64_tr_b16 v[90:91], v192 offset:1024
    v_mfma_f32_32x32x16_bf16 v[64:79], v[92:95], v[120:123], v[64:79]
    ds_read_b64_tr_b16 v[92:93], v193 offset:0
    ds_read_b64_tr_b16 v[94:95], v193 offset:1024
    s_waitcnt lgkmcnt(15)
    v_mfma_f32_32x32x16_bf16 v[16:31], v[96:99], v[124:127], v[16:31]
    ds_read_b64_tr_b16 v[96:97], v190 offset:4096
    ds_read_b64_tr_b16 v[98:99], v190 offset:5120
    ds_read_b128 v[136:139], v188
    v_mfma_f32_32x32x16_bf16 v[32:47], v[100:103], v[124:127], v[32:47]
    ds_read_b64_tr_b16 v[100:101], v191 offset:4096
    ds_read_b64_tr_b16 v[102:103], v191 offset:5120
    ds_read_b128 v[140:143], v189
    s_waitcnt lgkmcnt(15)
    v_mfma_f32_32x32x16_bf16 v[48:63], v[104:107], v[124:127], v[48:63]
    ds_read_b64_tr_b16 v[104:105], v192 offset:4096
    ds_read_b64_tr_b16 v[106:107], v192 offset:5120
    v_mfma_f32_32x32x16_bf16 v[64:79], v[108:111], v[124:127], v[64:79]
    ds_read_b64_tr_b16 v[108:109], v193 offset:4096
    ds_read_b64_tr_b16 v[110:111], v193 offset:5120
    s_waitcnt lgkmcnt(15)
    v_mfma_f32_32x32x16_bf16 v[16:31], v[80:83], v[128:131], v[16:31]
    ds_read_b64_tr_b16 v[80:81], v190 offset:8192
    ds_read_b64_tr_b16 v[82:83], v190 offset:9216
    v_mfma_f32_32x32x16_bf16 v[32:47], v[84:87], v[128:131], v[32:47]
    ds_read_b64_tr_b16 v[84:85], v191 offset:8192
    ds_read_b64_tr_b16 v[86:87], v191 offset:9216
    buffer_load_dword v10, v201, s[48:51], 0 offen sc1
    s_waitcnt lgkmcnt(15)
    v_mfma_f32_32x32x16_bf16 v[48:63], v[88:91], v[128:131], v[48:63]
    ds_read_b64_tr_b16 v[88:89], v192 offset:8192
    ds_read_b64_tr_b16 v[90:91], v192 offset:9216
    s_waitcnt lgkmcnt(15)
    v_mfma_f32_32x32x16_bf16 v[64:79], v[92:95], v[128:131], v[64:79]
    ds_read_b64_tr_b16 v[92:93], v193 offset:8192
    ds_read_b64_tr_b16 v[94:95], v193 offset:9216
    s_waitcnt lgkmcnt(15)
    v_mfma_f32_32x32x16_bf16 v[16:31], v[96:99], v[132:135], v[16:31]
    ds_read_b64_tr_b16 v[96:97], v190 offset:12288
    ds_read_b64_tr_b16 v[98:99], v190 offset:13312
    s_waitcnt lgkmcnt(15)
    v_mfma_f32_32x32x16_bf16 v[32:47], v[100:103], v[132:135], v[32:47]
    ds_read_b64_tr_b16 v[100:101], v191 offset:12288
    ds_read_b64_tr_b16 v[102:103], v191 offset:13312
    s_waitcnt lgkmcnt(14)
    v_mfma_f32_32x32x16_bf16 v[48:63], v[104:107], v[132:135], v[48:63]
    ds_read_b64_tr_b16 v[104:105], v192 offset:12288
    ds_read_b64_tr_b16 v[106:107], v192 offset:13312
    s_waitcnt lgkmcnt(14)
    v_mfma_f32_32x32x16_bf16 v[64:79], v[108:111], v[132:135], v[64:79]
    ds_read_b64_tr_b16 v[108:109], v193 offset:12288
    ds_read_b64_tr_b16 v[110:111], v193 offset:13312
    s_waitcnt vmcnt(2)
    s_barrier
    s_waitcnt lgkmcnt(14)
    v_mfma_f32_32x32x16_bf16 v[16:31], v[80:83], v[136:139], v[16:31]
    ds_read_b64_tr_b16 v[112:113], v194 offset:16384
    ds_read_b64_tr_b16 v[114:115], v194 offset:16704
    ds_read_b64_tr_b16 v[120:121], v194 offset:17024
    ds_read_b64_tr_b16 v[122:123], v194 offset:17344
    ds_read_b64_tr_b16 v[124:125], v194 offset:17664
    v_mov_b32 v118, 0
    v_mov_b32 v119, 0
    v_mov_b32 v126, 0
    v_mov_b32 v127, 0
    s_waitcnt lgkmcnt(15)
    v_mfma_f32_32x32x16_bf16 v[32:47], v[84:87], v[136:139], v[32:47]
    ds_read_b64_tr_b16 v[216:217], v207 offset:16384
    ds_read_b64_tr_b16 v[218:219], v207 offset:16704
    ds_read_b64_tr_b16 v[224:225], v207 offset:17024
    ds_read_b64_tr_b16 v[226:227], v207 offset:17344
    ds_read_b64_tr_b16 v[228:229], v207 offset:17664
    v_mov_b32 v222, 0
    v_mov_b32 v223, 0
    v_mov_b32 v230, 0
    v_mov_b32 v231, 0
    v_mfma_f32_32x32x16_bf16 v[48:63], v[88:91], v[136:139], v[48:63]
    s_waitcnt lgkmcnt(15)
    v_mfma_f32_32x32x16_bf16 v[64:79], v[92:95], v[136:139], v[64:79]
    ds_write_b64 v197, v[208:209] offset:272
    s_waitcnt lgkmcnt(15)
    v_mfma_f32_32x32x16_bf16 v[32:47], v[100:103], v[140:143], v[32:47]
    s_waitcnt lgkmcnt(8)
    v_cndmask_b32 v116, v120, 0, s[14:15]
    v_cndmask_b32 v120, 0, v120, s[14:15]
    v_cndmask_b32 v117, v121, 0, s[14:15]
    v_cndmask_b32 v121, 0, v121, s[14:15]
    v_mfma_f32_32x32x16_bf16 v[48:63], v[104:107], v[140:143], v[48:63]
    s_waitcnt lgkmcnt(3)
    v_cndmask_b32 v220, v224, 0, s[14:15]
    v_cndmask_b32 v224, 0, v224, s[14:15]
    v_cndmask_b32 v221, v225, 0, s[14:15]
    v_cndmask_b32 v225, 0, v225, s[14:15]
    v_mfma_f32_32x32x16_bf16 v[64:79], v[108:111], v[140:143], v[64:79]
    v_mfma_f32_32x32x16_bf16 v[16:31], v[96:99], v[140:143], v[16:31]
    buffer_store_dwordx4 v[212:215], v205, s[48:51], s72 offen sc1
    buffer_store_dwordx4 v[212:215], v205, s[48:51], s72 offen offset:256 sc1
    buffer_store_dwordx2 v[212:213], v206, s[48:51], s72 offen offset:1024 sc1
    v_cvt_pk_bf16_f32 v156, v40, v41
    v_cvt_pk_bf16_f32 v157, v42, v43
    v_cvt_pk_bf16_f32 v158, v44, v45
    v_cvt_pk_bf16_f32 v159, v46, v47
    v_cvt_pk_bf16_f32 v160, v48, v49
    v_cvt_pk_bf16_f32 v161, v50, v51
    v_cvt_pk_bf16_f32 v162, v52, v53
    v_cvt_pk_bf16_f32 v163, v54, v55
    v_mfma_f32_32x32x16_bf16 v[80:95], v[112:115], v[156:159], 0
    s_nop 0
    v_mfma_f32_32x32x16_bf16 v[80:95], v[116:119], v[160:163], v[80:95]
    v_cvt_pk_bf16_f32 v164, v56, v57
    v_cvt_pk_bf16_f32 v165, v58, v59
    v_cvt_pk_bf16_f32 v166, v60, v61
    v_cvt_pk_bf16_f32 v167, v62, v63
    v_mfma_f32_32x32x16_bf16 v[96:111], v[120:123], v[160:163], 0
    s_nop 0
    v_mfma_f32_32x32x16_bf16 v[96:111], v[124:127], v[164:167], v[96:111]
    v_cvt_pk_bf16_f32 v168, v64, v65
    v_cvt_pk_bf16_f32 v169, v66, v67
    v_cvt_pk_bf16_f32 v170, v68, v69
    v_cvt_pk_bf16_f32 v171, v70, v71
    v_cvt_pk_bf16_f32 v172, v72, v73
    v_cvt_pk_bf16_f32 v173, v74, v75
    v_cvt_pk_bf16_f32 v174, v76, v77
    v_cvt_pk_bf16_f32 v175, v78, v79
    ds_write2_b64 v196, v[166:167], v[168:169] offset0:24 offset1:26
    ds_write2_b64 v196, v[170:171], v[172:173] offset0:28 offset1:30
    ds_write_b64 v196, v[174:175] offset:256
    v_cndmask_b32 v88, v88, v90, s[14:15]
    v_cndmask_b32 v89, v89, v91, s[14:15]
    v_cvt_pk_bf16_f32 v81, v80, v81
    v_cvt_pk_bf16_f32 v83, v82, v83
    v_cvt_pk_bf16_f32 v85, v84, v85
    v_cvt_pk_bf16_f32 v87, v86, v87
    v_cvt_pk_bf16_f32 v89, v88, v89
    v_lshlrev_b32 v80, 16, v81
    v_and_b32 v81, 0xffff0000, v81
    v_lshlrev_b32 v82, 16, v83
    v_and_b32 v83, 0xffff0000, v83
    v_lshlrev_b32 v84, 16, v85
    v_and_b32 v85, 0xffff0000, v85
    v_lshlrev_b32 v86, 16, v87
    v_and_b32 v87, 0xffff0000, v87
    v_lshlrev_b32 v88, 16, v89
    v_and_b32 v89, 0xffff0000, v89
    v_max3_f32 v58, v80, v81, v82
    v_max3_f32 v94, -v80, -v81, -v82
    v_max3_f32 v58, v58, v83, v84
    v_max3_f32 v94, v94, -v83, -v84
    v_max3_f32 v58, v58, v85, v86
    v_max3_f32 v94, v94, -v85, -v86
    v_max3_f32 v58, v58, v87, v88
    v_max3_f32 v94, v94, -v87, -v88
    v_max_f32 v58, v58, v89
    v_max_f32 v94, v94, -v89
    s_nop 1
    v_permlane32_swap_b32 v58, v94
    v_max_f32 v58, v58, v94
    v_mul_f32 v58, s13, v58
    v_mov_b32 v94, v58
    s_nop 1
    v_permlane32_swap_b32 v58, v94
    v_pk_fma_f32 v[48:49], v[80:81], s[12:13], v[94:95] op_sel_hi:[1,0,0] neg_lo:[1,0,0] neg_hi:[1,0,0]
    v_pk_fma_f32 v[50:51], v[82:83], s[12:13], v[94:95] op_sel_hi:[1,0,0] neg_lo:[1,0,0] neg_hi:[1,0,0]
    v_pk_fma_f32 v[52:53], v[84:85], s[12:13], v[94:95] op_sel_hi:[1,0,0] neg_lo:[1,0,0] neg_hi:[1,0,0]
    v_pk_fma_f32 v[54:55], v[86:87], s[12:13], v[94:95] op_sel_hi:[1,0,0] neg_lo:[1,0,0] neg_hi:[1,0,0]
    v_pk_fma_f32 v[56:57], v[88:89], s[12:13], v[94:95] op_sel_hi:[1,0,0] neg_lo:[1,0,0] neg_hi:[1,0,0]
    v_pk_fma_f32 v[80:81], v[80:81], s[12:13], v[58:59] op_sel_hi:[1,0,0]
    v_pk_fma_f32 v[82:83], v[82:83], s[12:13], v[58:59] op_sel_hi:[1,0,0]
    v_pk_fma_f32 v[84:85], v[84:85], s[12:13], v[58:59] op_sel_hi:[1,0,0]
    v_pk_fma_f32 v[86:87], v[86:87], s[12:13], v[58:59] op_sel_hi:[1,0,0]
    v_pk_fma_f32 v[88:89], v[88:89], s[12:13], v[58:59] op_sel_hi:[1,0,0]
    v_exp_f32 v80, v80
    v_exp_f32 v48, v48
    v_exp_f32 v81, v81
    v_exp_f32 v49, v49
    v_exp_f32 v82, v82
    v_exp_f32 v50, v50
    v_exp_f32 v83, v83
    v_exp_f32 v51, v51
    v_exp_f32 v84, v84
    v_exp_f32 v52, v52
    v_exp_f32 v85, v85
    v_exp_f32 v53, v53
    v_exp_f32 v86, v86
    v_exp_f32 v54, v54
    v_exp_f32 v87, v87
    v_exp_f32 v55, v55
    v_exp_f32 v88, v88
    v_exp_f32 v56, v56
    v_exp_f32 v89, v89
    v_exp_f32 v57, v57
    v_pk_add_f32 v[90:91], v[80:81], v[82:83]
    v_pk_add_f32 v[92:93], v[48:49], v[50:51]
    v_pk_add_f32 v[90:91], v[90:91], v[84:85]
    v_pk_add_f32 v[92:93], v[92:93], v[52:53]
    v_pk_add_f32 v[90:91], v[90:91], v[86:87]
    v_pk_add_f32 v[92:93], v[92:93], v[54:55]
    v_pk_add_f32 v[90:91], v[90:91], v[88:89]
    v_pk_add_f32 v[92:93], v[92:93], v[56:57]
    v_add_f32 v58, v90, v91
    v_add_f32 v94, v92, v93
    s_nop 1
    v_permlane32_swap_b32 v58, v94
    v_add_f32 v58, v58, v94
    v_rcp_f32 v58, v58
    s_nop 0
    v_mov_b32 v94, v58
    s_nop 1
    v_permlane32_swap_b32 v58, v94
    v_pk_mul_f32 v[80:81], v[80:81], v[58:59] op_sel_hi:[1,0]
    v_pk_mul_f32 v[48:49], v[48:49], v[94:95] op_sel_hi:[1,0]
    v_pk_mul_f32 v[82:83], v[82:83], v[58:59] op_sel_hi:[1,0]
    v_pk_mul_f32 v[50:51], v[50:51], v[94:95] op_sel_hi:[1,0]
    v_pk_mul_f32 v[84:85], v[84:85], v[58:59] op_sel_hi:[1,0]
    v_pk_mul_f32 v[52:53], v[52:53], v[94:95] op_sel_hi:[1,0]
    v_pk_mul_f32 v[86:87], v[86:87], v[58:59] op_sel_hi:[1,0]
    v_pk_mul_f32 v[54:55], v[54:55], v[94:95] op_sel_hi:[1,0]
    v_pk_mul_f32 v[88:89], v[88:89], v[58:59] op_sel_hi:[1,0]
    v_pk_mul_f32 v[56:57], v[56:57], v[94:95] op_sel_hi:[1,0]
    v_cvt_pk_bf16_f32 v60, v80, v81
    v_cvt_pk_bf16_f32 v61, v82, v83
    v_cvt_pk_bf16_f32 v62, v84, v85
    v_cvt_pk_bf16_f32 v63, v86, v87
    v_cvt_pk_bf16_f32 v64, v88, v89
    v_cvt_pk_bf16_f32 v65, v48, v49
    v_cvt_pk_bf16_f32 v66, v50, v51
    v_cvt_pk_bf16_f32 v67, v52, v53
    v_cvt_pk_bf16_f32 v68, v54, v55
    v_cvt_pk_bf16_f32 v69, v56, v57
    ds_write_b128 v195, v[60:63] offset:0
    ds_write_b128 v195, v[64:67] offset:16
    ds_write_b64 v195, v[68:69] offset:32
    v_cndmask_b32 v104, v104, v106, s[14:15]
    v_cndmask_b32 v105, v105, v107, s[14:15]
    v_cvt_pk_bf16_f32 v97, v96, v97
    v_cvt_pk_bf16_f32 v99, v98, v99
    v_cvt_pk_bf16_f32 v101, v100, v101
    v_cvt_pk_bf16_f32 v103, v102, v103
    v_cvt_pk_bf16_f32 v105, v104, v105
    v_lshlrev_b32 v96, 16, v97
    v_and_b32 v97, 0xffff0000, v97
    v_lshlrev_b32 v98, 16, v99
    v_and_b32 v99, 0xffff0000, v99
    v_lshlrev_b32 v100, 16, v101
    v_and_b32 v101, 0xffff0000, v101
    v_lshlrev_b32 v102, 16, v103
    v_and_b32 v103, 0xffff0000, v103
    v_lshlrev_b32 v104, 16, v105
    v_and_b32 v105, 0xffff0000, v105
    v_max3_f32 v58, v96, v97, v98
    v_max3_f32 v110, -v96, -v97, -v98
    v_max3_f32 v58, v58, v99, v100
    v_max3_f32 v110, v110, -v99, -v100
    v_max3_f32 v58, v58, v101, v102
    v_max3_f32 v110, v110, -v101, -v102
    v_max3_f32 v58, v58, v103, v104
    v_max3_f32 v110, v110, -v103, -v104
    v_max_f32 v58, v58, v105
    v_max_f32 v110, v110, -v105
    s_nop 1
    v_permlane32_swap_b32 v58, v110
    v_max_f32 v58, v58, v110
    v_mul_f32 v58, s13, v58
    v_mov_b32 v110, v58
    s_nop 1
    v_permlane32_swap_b32 v58, v110
    v_pk_fma_f32 v[48:49], v[96:97], s[12:13], v[110:111] op_sel_hi:[1,0,0] neg_lo:[1,0,0] neg_hi:[1,0,0]
    v_pk_fma_f32 v[50:51], v[98:99], s[12:13], v[110:111] op_sel_hi:[1,0,0] neg_lo:[1,0,0] neg_hi:[1,0,0]
    v_pk_fma_f32 v[52:53], v[100:101], s[12:13], v[110:111] op_sel_hi:[1,0,0] neg_lo:[1,0,0] neg_hi:[1,0,0]
    v_pk_fma_f32 v[54:55], v[102:103], s[12:13], v[110:111] op_sel_hi:[1,0,0] neg_lo:[1,0,0] neg_hi:[1,0,0]
    v_pk_fma_f32 v[56:57], v[104:105], s[12:13], v[110:111] op_sel_hi:[1,0,0] neg_lo:[1,0,0] neg_hi:[1,0,0]
    v_pk_fma_f32 v[96:97], v[96:97], s[12:13], v[58:59] op_sel_hi:[1,0,0]
    v_pk_fma_f32 v[98:99], v[98:99], s[12:13], v[58:59] op_sel_hi:[1,0,0]
    v_pk_fma_f32 v[100:101], v[100:101], s[12:13], v[58:59] op_sel_hi:[1,0,0]
    v_pk_fma_f32 v[102:103], v[102:103], s[12:13], v[58:59] op_sel_hi:[1,0,0]
    v_pk_fma_f32 v[104:105], v[104:105], s[12:13], v[58:59] op_sel_hi:[1,0,0]
    v_exp_f32 v96, v96
    v_exp_f32 v48, v48
    v_exp_f32 v97, v97
    v_exp_f32 v49, v49
    v_exp_f32 v98, v98
    v_exp_f32 v50, v50
    v_exp_f32 v99, v99
    v_exp_f32 v51, v51
    v_exp_f32 v100, v100
    v_exp_f32 v52, v52
    v_exp_f32 v101, v101
    v_exp_f32 v53, v53
    v_exp_f32 v102, v102
    v_exp_f32 v54, v54
    v_exp_f32 v103, v103
    v_exp_f32 v55, v55
    v_exp_f32 v104, v104
    v_exp_f32 v56, v56
    v_exp_f32 v105, v105
    v_exp_f32 v57, v57
    v_pk_add_f32 v[106:107], v[96:97], v[98:99]
    v_pk_add_f32 v[108:109], v[48:49], v[50:51]
    v_pk_add_f32 v[106:107], v[106:107], v[100:101]
    v_pk_add_f32 v[108:109], v[108:109], v[52:53]
    v_pk_add_f32 v[106:107], v[106:107], v[102:103]
    v_pk_add_f32 v[108:109], v[108:109], v[54:55]
    v_pk_add_f32 v[106:107], v[106:107], v[104:105]
    v_pk_add_f32 v[108:109], v[108:109], v[56:57]
    v_add_f32 v58, v106, v107
    v_add_f32 v110, v108, v109
    s_nop 1
    v_permlane32_swap_b32 v58, v110
    v_add_f32 v58, v58, v110
    v_rcp_f32 v58, v58
    s_nop 0
    v_mov_b32 v110, v58
    s_nop 1
    v_permlane32_swap_b32 v58, v110
    v_pk_mul_f32 v[96:97], v[96:97], v[58:59] op_sel_hi:[1,0]
    v_pk_mul_f32 v[48:49], v[48:49], v[110:111] op_sel_hi:[1,0]
    v_pk_mul_f32 v[98:99], v[98:99], v[58:59] op_sel_hi:[1,0]
    v_pk_mul_f32 v[50:51], v[50:51], v[110:111] op_sel_hi:[1,0]
    v_pk_mul_f32 v[100:101], v[100:101], v[58:59] op_sel_hi:[1,0]
    v_pk_mul_f32 v[52:53], v[52:53], v[110:111] op_sel_hi:[1,0]
    v_pk_mul_f32 v[102:103], v[102:103], v[58:59] op_sel_hi:[1,0]
    v_pk_mul_f32 v[54:55], v[54:55], v[110:111] op_sel_hi:[1,0]
    v_pk_mul_f32 v[104:105], v[104:105], v[58:59] op_sel_hi:[1,0]
    v_pk_mul_f32 v[56:57], v[56:57], v[110:111] op_sel_hi:[1,0]
    v_cvt_pk_bf16_f32 v70, v96, v97
    v_cvt_pk_bf16_f32 v71, v98, v99
    v_cvt_pk_bf16_f32 v72, v100, v101
    v_cvt_pk_bf16_f32 v73, v102, v103
    v_cvt_pk_bf16_f32 v74, v104, v105
    v_cvt_pk_bf16_f32 v75, v48, v49
    v_cvt_pk_bf16_f32 v76, v50, v51
    v_cvt_pk_bf16_f32 v77, v52, v53
    v_cvt_pk_bf16_f32 v78, v54, v55
    v_cvt_pk_bf16_f32 v79, v56, v57
    ds_write_b128 v195, v[70:73] offset:96
    ds_write_b128 v195, v[74:77] offset:112
    ds_write_b64 v195, v[78:79] offset:128
    v_cvt_pk_bf16_f32 v144, v16, v17
    v_cvt_pk_bf16_f32 v145, v18, v19
    v_cvt_pk_bf16_f32 v146, v20, v21
    v_cvt_pk_bf16_f32 v147, v22, v23
    v_cvt_pk_bf16_f32 v148, v24, v25
    v_cvt_pk_bf16_f32 v149, v26, v27
    v_cvt_pk_bf16_f32 v150, v28, v29
    v_cvt_pk_bf16_f32 v151, v30, v31
    v_mfma_f32_32x32x16_bf16 v[16:31], v[216:219], v[144:147], 0
    s_waitcnt lgkmcnt(0)
    s_barrier
    ds_read_b64_tr_b16 v[48:49], v198 offset:0
    ds_read_b64_tr_b16 v[50:51], v198 offset:1344
    ds_read_b64_tr_b16 v[52:53], v199 offset:0
    ds_read_b64_tr_b16 v[54:55], v199 offset:1344
    ds_read_b64_tr_b16 v[56:57], v198 offset:5376
    ds_read_b64_tr_b16 v[58:59], v198 offset:6720
    ds_read_b64_tr_b16 v[60:61], v199 offset:5376
    ds_read_b64_tr_b16 v[62:63], v199 offset:6720
    ds_read_b64_tr_b16 v[64:65], v198 offset:10752
    ds_read_b64_tr_b16 v[66:67], v198 offset:12096
    ds_read_b64_tr_b16 v[68:69], v199 offset:10752
    ds_read_b64_tr_b16 v[70:71], v199 offset:12096
    ds_read_b64_tr_b16 v[72:73], v198 offset:16128
    ds_read_b64_tr_b16 v[74:75], v198 offset:17472
    ds_read_b64_tr_b16 v[76:77], v199 offset:16128
    ds_read_b64_tr_b16 v[78:79], v199 offset:17472
    v_cvt_pk_bf16_f32 v152, v32, v33
    v_cvt_pk_bf16_f32 v153, v34, v35
    v_cvt_pk_bf16_f32 v154, v36, v37
    v_cvt_pk_bf16_f32 v155, v38, v39
    v_mfma_f32_32x32x16_bf16 v[16:31], v[220:223], v[148:151], v[16:31]
    v_mfma_f32_32x32x16_bf16 v[32:47], v[224:227], v[148:151], 0
    v_mfma_f32_32x32x16_bf16 v[32:47], v[228:231], v[152:155], v[32:47]
    s_waitcnt vmcnt(3)
    v_cmp_ne_u32 vcc, s79, v10
    s_mov_b32 s68, 20000
L_flg9:
    s_nop 1
    s_cmp_eq_u64 vcc, 0
    s_cbranch_scc1 L_flg9_done
    s_sleep 8
    buffer_load_dword v10, v201, s[48:51], 0 offen sc1
    s_waitcnt vmcnt(0)
    v_cmp_ne_u32 vcc, s79, v10
    s_sub_u32 s68, s68, 1
    s_cmp_lg_u32 s68, 0
    s_cbranch_scc1 L_flg9
L_flg9_done:
    s_mov_b32 s34, 16777215
    s_mov_b32 s35, 16777215
    v_mov_b32 v7, 33554432
    v_cndmask_b32 v8, v7, v200, s[34:35]
    v_cndmask_b32 v7, v8, v7, s[14:15]
    s_mov_b32 s34, 14680064
    s_mov_b32 s35, 14680064
    s_nop 0
    v_cndmask_b32 v24, v24, v26, s[14:15]
    v_cndmask_b32 v25, v25, v27, s[14:15]
    v_cvt_pk_bf16_f32 v17, v16, v17
    v_cvt_pk_bf16_f32 v19, v18, v19
    v_cvt_pk_bf16_f32 v21, v20, v21
    v_cvt_pk_bf16_f32 v23, v22, v23
    v_cvt_pk_bf16_f32 v25, v24, v25
    s_waitcnt lgkmcnt(12)
    v_mfma_f32_32x32x16_bf16 v[80:95], v[48:51], v[52:55], 0
    ds_read_b64_tr_b16 v[96:97], v198 offset:21504
    ds_read_b64_tr_b16 v[98:99], v198 offset:22848
    ds_read_b64_tr_b16 v[100:101], v199 offset:21504
    ds_read_b64_tr_b16 v[102:103], v199 offset:22848
    v_lshlrev_b32 v16, 16, v17
    v_and_b32 v17, 0xffff0000, v17
    v_lshlrev_b32 v18, 16, v19
    v_and_b32 v19, 0xffff0000, v19
    v_lshlrev_b32 v20, 16, v21
    v_and_b32 v21, 0xffff0000, v21
    v_lshlrev_b32 v22, 16, v23
    s_waitcnt lgkmcnt(12)
    v_mfma_f32_32x32x16_bf16 v[80:95], v[56:59], v[60:63], v[80:95]
    ds_read_b64_tr_b16 v[104:105], v198 offset:26880
    ds_read_b64_tr_b16 v[106:107], v198 offset:28224
    ds_read_b64_tr_b16 v[108:109], v199 offset:26880
    ds_read_b64_tr_b16 v[110:111], v199 offset:28224
    v_and_b32 v23, 0xffff0000, v23
    v_lshlrev_b32 v24, 16, v25
    v_and_b32 v25, 0xffff0000, v25
    v_max3_f32 v166, v16, v17, v18
    v_max3_f32 v30, -v16, -v17, -v18
    v_max3_f32 v166, v166, v19, v20
    v_max3_f32 v30, v30, -v19, -v20
    s_waitcnt lgkmcnt(12)
    v_mfma_f32_32x32x16_bf16 v[80:95], v[64:67], v[68:71], v[80:95]
    ds_read_b64_tr_b16 v[112:113], v198 offset:32256
    ds_read_b64_tr_b16 v[114:115], v198 offset:33600
    ds_read_b64_tr_b16 v[116:117], v199 offset:32256
    ds_read_b64_tr_b16 v[118:119], v199 offset:33600
    v_max3_f32 v166, v166, v21, v22
    v_max3_f32 v30, v30, -v21, -v22
    v_max3_f32 v166, v166, v23, v24
    v_max3_f32 v30, v30, -v23, -v24
    v_max_f32 v166, v166, v25
    v_max_f32 v30, v30, -v25
    s_nop 1
    v_permlane32_swap_b32 v166, v30
    s_waitcnt lgkmcnt(12)
    v_mfma_f32_32x32x16_bf16 v[80:95], v[72:75], v[76:79], v[80:95]
    ds_read_b64_tr_b16 v[120:121], v198 offset:37632
    ds_read_b64_tr_b16 v[122:123], v198 offset:38976
    ds_read_b64_tr_b16 v[124:125], v199 offset:37632
    ds_read_b64_tr_b16 v[126:127], v199 offset:38976
    v_max_f32 v166, v166, v30
    v_mul_f32 v166, s13, v166
    v_mov_b32 v30, v166
    s_nop 1
    v_permlane32_swap_b32 v166, v30
    v_pk_fma_f32 v[156:157], v[16:17], s[12:13], v[30:31] op_sel_hi:[1,0,0] neg_lo:[1,0,0] neg_hi:[1,0,0]
    v_pk_fma_f32 v[158:159], v[18:19], s[12:13], v[30:31] op_sel_hi:[1,0,0] neg_lo:[1,0,0] neg_hi:[1,0,0]
    v_pk_fma_f32 v[160:161], v[20:21], s[12:13], v[30:31] op_sel_hi:[1,0,0] neg_lo:[1,0,0] neg_hi:[1,0,0]
    s_waitcnt lgkmcnt(12)
    v_mfma_f32_32x32x16_bf16 v[80:95], v[96:99], v[100:103], v[80:95]
    v_pk_fma_f32 v[162:163], v[22:23], s[12:13], v[30:31] op_sel_hi:[1,0,0] neg_lo:[1,0,0] neg_hi:[1,0,0]
    v_pk_fma_f32 v[164:165], v[24:25], s[12:13], v[30:31] op_sel_hi:[1,0,0] neg_lo:[1,0,0] neg_hi:[1,0,0]
    v_pk_fma_f32 v[16:17], v[16:17], s[12:13], v[166:167] op_sel_hi:[1,0,0]
    v_pk_fma_f32 v[18:19], v[18:19], s[12:13], v[166:167] op_sel_hi:[1,0,0]
    v_pk_fma_f32 v[20:21], v[20:21], s[12:13], v[166:167] op_sel_hi:[1,0,0]
    v_pk_fma_f32 v[22:23], v[22:23], s[12:13], v[166:167] op_sel_hi:[1,0,0]
    v_pk_fma_f32 v[24:25], v[24:25], s[12:13], v[166:167] op_sel_hi:[1,0,0]
    s_waitcnt lgkmcnt(8)
    v_mfma_f32_32x32x16_bf16 v[80:95], v[104:107], v[108:111], v[80:95]
    v_exp_f32 v16, v16
    v_exp_f32 v156, v156
    v_exp_f32 v17, v17
    v_exp_f32 v157, v157
    v_exp_f32 v18, v18
    v_exp_f32 v158, v158
    v_exp_f32 v19, v19
    s_waitcnt lgkmcnt(4)
    v_mfma_f32_32x32x16_bf16 v[80:95], v[112:115], v[116:119], v[80:95]
    v_exp_f32 v159, v159
    v_exp_f32 v20, v20
    v_exp_f32 v160, v160
    v_exp_f32 v21, v21
    v_exp_f32 v161, v161
    v_exp_f32 v22, v22
    v_exp_f32 v162, v162
    s_waitcnt lgkmcnt(0)
    v_mfma_f32_32x32x16_bf16 v[80:95], v[120:123], v[124:127], v[80:95]
    v_exp_f32 v23, v23
    v_exp_f32 v163, v163
    v_exp_f32 v24, v24
    v_exp_f32 v164, v164
    v_exp_f32 v25, v25
    v_exp_f32 v165, v165
    v_pk_add_f32 v[26:27], v[16:17], v[18:19]
    v_pk_add_f32 v[28:29], v[156:157], v[158:159]
    v_pk_add_f32 v[26:27], v[26:27], v[20:21]
    v_pk_add_f32 v[28:29], v[28:29], v[160:161]
    v_pk_add_f32 v[26:27], v[26:27], v[22:23]
    v_pk_add_f32 v[28:29], v[28:29], v[162:163]
    v_pk_add_f32 v[26:27], v[26:27], v[24:25]
    v_pk_add_f32 v[28:29], v[28:29], v[164:165]
    v_add_f32 v166, v26, v27
    v_add_f32 v30, v28, v29
    s_nop 1
    v_permlane32_swap_b32 v166, v30
    v_add_f32 v166, v166, v30
    v_rcp_f32 v166, v166
    s_nop 0
    v_mov_b32 v30, v166
    s_nop 1
    v_permlane32_swap_b32 v166, v30
    v_cndmask_b32 v80, v80, 1.0, s[34:35]
    buffer_atomic_add_f32 v80, v8, s[48:51], s70 offen offset:0
    v_pk_mul_f32 v[16:17], v[16:17], v[166:167] op_sel_hi:[1,0]
    v_pk_mul_f32 v[156:157], v[156:157], v[30:31] op_sel_hi:[1,0]
    v_pk_mul_f32 v[18:19], v[18:19], v[166:167] op_sel_hi:[1,0]
    v_pk_mul_f32 v[158:159], v[158:159], v[30:31] op_sel_hi:[1,0]
    v_pk_mul_f32 v[20:21], v[20:21], v[166:167] op_sel_hi:[1,0]
    v_pk_mul_f32 v[160:161], v[160:161], v[30:31] op_sel_hi:[1,0]
    v_pk_mul_f32 v[22:23], v[22:23], v[166:167] op_sel_hi:[1,0]
    v_cndmask_b32 v81, v81, 1.0, s[34:35]
    buffer_atomic_add_f32 v81, v8, s[48:51], s70 offen offset:192
    v_pk_mul_f32 v[162:163], v[162:163], v[30:31] op_sel_hi:[1,0]
    v_pk_mul_f32 v[24:25], v[24:25], v[166:167] op_sel_hi:[1,0]
    v_pk_mul_f32 v[164:165], v[164:165], v[30:31] op_sel_hi:[1,0]
    v_cvt_pk_bf16_f32 v128, v16, v17
    v_cvt_pk_bf16_f32 v129, v18, v19
    v_cvt_pk_bf16_f32 v130, v20, v21
    v_cvt_pk_bf16_f32 v131, v22, v23
    v_cndmask_b32 v82, v82, 1.0, s[34:35]
    buffer_atomic_add_f32 v82, v8, s[48:51], s70 offen offset:384
    v_cvt_pk_bf16_f32 v132, v24, v25
    v_cvt_pk_bf16_f32 v133, v156, v157
    v_cvt_pk_bf16_f32 v134, v158, v159
    v_cvt_pk_bf16_f32 v135, v160, v161
    v_cvt_pk_bf16_f32 v136, v162, v163
    v_cvt_pk_bf16_f32 v137, v164, v165
    v_cndmask_b32 v40, v40, v42, s[14:15]
    v_cndmask_b32 v41, v41, v43, s[14:15]
    v_cvt_pk_bf16_f32 v33, v32, v33
    v_cvt_pk_bf16_f32 v35, v34, v35
    v_cvt_pk_bf16_f32 v37, v36, v37
    v_cvt_pk_bf16_f32 v39, v38, v39
    v_cndmask_b32 v83, v83, 1.0, s[34:35]
    buffer_atomic_add_f32 v83, v8, s[48:51], s70 offen offset:576
    v_cvt_pk_bf16_f32 v41, v40, v41
    v_lshlrev_b32 v32, 16, v33
    v_and_b32 v33, 0xffff0000, v33
    v_lshlrev_b32 v34, 16, v35
    v_and_b32 v35, 0xffff0000, v35
    v_lshlrev_b32 v36, 16, v37
    v_cndmask_b32 v84, v84, 1.0, s[34:35]
    buffer_atomic_add_f32 v84, v8, s[48:51], s70 offen offset:768
    v_and_b32 v37, 0xffff0000, v37
    v_lshlrev_b32 v38, 16, v39
    v_and_b32 v39, 0xffff0000, v39
    v_lshlrev_b32 v40, 16, v41
    v_and_b32 v41, 0xffff0000, v41
    v_max3_f32 v166, v32, v33, v34
    v_cndmask_b32 v85, v85, 1.0, s[34:35]
    buffer_atomic_add_f32 v85, v8, s[48:51], s70 offen offset:960
    v_max3_f32 v46, -v32, -v33, -v34
    v_max3_f32 v166, v166, v35, v36
    v_max3_f32 v46, v46, -v35, -v36
    v_max3_f32 v166, v166, v37, v38
    v_max3_f32 v46, v46, -v37, -v38
    v_max3_f32 v166, v166, v39, v40
    v_cndmask_b32 v86, v86, 1.0, s[34:35]
    buffer_atomic_add_f32 v86, v8, s[48:51], s70 offen offset:1152
    v_max3_f32 v46, v46, -v39, -v40
    v_max_f32 v166, v166, v41
    v_max_f32 v46, v46, -v41
    s_nop 1
    v_permlane32_swap_b32 v166, v46
    v_max_f32 v166, v166, v46
    v_mul_f32 v166, s13, v166
    v_cndmask_b32 v87, v87, 1.0, s[34:35]
    buffer_atomic_add_f32 v87, v8, s[48:51], s70 offen offset:1344
    v_mov_b32 v46, v166
    s_nop 1
    v_permlane32_swap_b32 v166, v46
    v_pk_fma_f32 v[156:157], v[32:33], s[12:13], v[46:47] op_sel_hi:[1,0,0] neg_lo:[1,0,0] neg_hi:[1,0,0]
    v_pk_fma_f32 v[158:159], v[34:35], s[12:13], v[46:47] op_sel_hi:[1,0,0] neg_lo:[1,0,0] neg_hi:[1,0,0]
    v_pk_fma_f32 v[160:161], v[36:37], s[12:13], v[46:47] op_sel_hi:[1,0,0] neg_lo:[1,0,0] neg_hi:[1,0,0]
    v_pk_fma_f32 v[162:163], v[38:39], s[12:13], v[46:47] op_sel_hi:[1,0,0] neg_lo:[1,0,0] neg_hi:[1,0,0]
    v_cndmask_b32 v88, v88, 1.0, s[34:35]
    buffer_atomic_add_f32 v88, v7, s[48:51], s70 offen offset:1536
    v_pk_fma_f32 v[164:165], v[40:41], s[12:13], v[46:47] op_sel_hi:[1,0,0] neg_lo:[1,0,0] neg_hi:[1,0,0]
    v_pk_fma_f32 v[32:33], v[32:33], s[12:13], v[166:167] op_sel_hi:[1,0,0]
    v_pk_fma_f32 v[34:35], v[34:35], s[12:13], v[166:167] op_sel_hi:[1,0,0]
    v_pk_fma_f32 v[36:37], v[36:37], s[12:13], v[166:167] op_sel_hi:[1,0,0]
    v_pk_fma_f32 v[38:39], v[38:39], s[12:13], v[166:167] op_sel_hi:[1,0,0]
    v_pk_fma_f32 v[40:41], v[40:41], s[12:13], v[166:167] op_sel_hi:[1,0,0]
    v_cndmask_b32 v89, v89, 1.0, s[34:35]
    buffer_atomic_add_f32 v89, v7, s[48:51], s70 offen offset:1728
    v_exp_f32 v32, v32
    v_exp_f32 v156, v156
    v_exp_f32 v33, v33
    v_exp_f32 v157, v157
    v_exp_f32 v34, v34
    v_exp_f32 v158, v158
    v_cndmask_b32 v90, v90, 1.0, s[34:35]
    buffer_atomic_add_f32 v90, v7, s[48:51], s70 offen offset:1920
    v_exp_f32 v35, v35
    v_exp_f32 v159, v159
    v_exp_f32 v36, v36
    v_exp_f32 v160, v160
    v_exp_f32 v37, v37
    v_exp_f32 v161, v161
    v_cndmask_b32 v91, v91, 1.0, s[34:35]
    buffer_atomic_add_f32 v91, v7, s[48:51], s70 offen offset:2112
    v_exp_f32 v38, v38
    v_exp_f32 v162, v162
    v_exp_f32 v39, v39
    v_exp_f32 v163, v163
    v_exp_f32 v40, v40
    v_exp_f32 v164, v164
    v_exp_f32 v41, v41
    v_exp_f32 v165, v165
    v_pk_add_f32 v[42:43], v[32:33], v[34:35]
    v_pk_add_f32 v[44:45], v[156:157], v[158:159]
    v_pk_add_f32 v[42:43], v[42:43], v[36:37]
    v_pk_add_f32 v[44:45], v[44:45], v[160:161]
    v_pk_add_f32 v[42:43], v[42:43], v[38:39]
    v_pk_add_f32 v[44:45], v[44:45], v[162:163]
    v_pk_add_f32 v[42:43], v[42:43], v[40:41]
    v_pk_add_f32 v[44:45], v[44:45], v[164:165]
    v_add_f32 v166, v42, v43
    v_add_f32 v46, v44, v45
    s_nop 1
    v_permlane32_swap_b32 v166, v46
    v_add_f32 v166, v166, v46
    v_rcp_f32 v166, v166
    s_nop 0
    v_mov_b32 v46, v166
    s_nop 1
    v_permlane32_swap_b32 v166, v46
    v_pk_mul_f32 v[32:33], v[32:33], v[166:167] op_sel_hi:[1,0]
    v_pk_mul_f32 v[156:157], v[156:157], v[46:47] op_sel_hi:[1,0]
    v_pk_mul_f32 v[34:35], v[34:35], v[166:167] op_sel_hi:[1,0]
    v_pk_mul_f32 v[158:159], v[158:159], v[46:47] op_sel_hi:[1,0]
    v_pk_mul_f32 v[36:37], v[36:37], v[166:167] op_sel_hi:[1,0]
    v_pk_mul_f32 v[160:161], v[160:161], v[46:47] op_sel_hi:[1,0]
    v_pk_mul_f32 v[38:39], v[38:39], v[166:167] op_sel_hi:[1,0]
    v_pk_mul_f32 v[162:163], v[162:163], v[46:47] op_sel_hi:[1,0]
    v_pk_mul_f32 v[40:41], v[40:41], v[166:167] op_sel_hi:[1,0]
    v_pk_mul_f32 v[164:165], v[164:165], v[46:47] op_sel_hi:[1,0]
    v_cvt_pk_bf16_f32 v138, v32, v33
    v_cvt_pk_bf16_f32 v139, v34, v35
    v_cvt_pk_bf16_f32 v140, v36, v37
    v_cvt_pk_bf16_f32 v141, v38, v39
    v_cvt_pk_bf16_f32 v142, v40, v41
    v_cvt_pk_bf16_f32 v143, v156, v157
    v_cvt_pk_bf16_f32 v144, v158, v159
    v_cvt_pk_bf16_f32 v145, v160, v161
    v_cvt_pk_bf16_f32 v146, v162, v163
    v_cvt_pk_bf16_f32 v147, v164, v165
    v_lshlrev_b32 v4, 4, v2
    v_mov_b32 v6, v202
    v_mov_b32 v3, v204
    v_mov_b32 v5, v205
    v_mov_b32 v9, v206
    v_mov_b32 v13, v210
    s_lshr_b32 s75, s9, 1
    s_lshl_b32 s75, s75, 2
    s_add_u32 s75, s75, s3
    s_mul_i32 s75, s75, 25600
    s_add_u32 s75, s75, 655360
    s_waitcnt vmcnt(12)
    v_mov_b32 v14, s79
    s_mov_b64 exec, 1
    buffer_store_dword v14, v15, s[48:51], s77 offen sc1
    s_mov_b64 exec, -1
    v_mov_b32 v58, 0
    v_mov_b32 v59, 0
    v_mov_b32 v60, 0
    v_mov_b32 v61, 0
    buffer_load_dwordx4 v[156:159], v4, s[48:51], s75 offen offset:0 sc1
    buffer_load_dwordx4 v[160:163], v4, s[48:51], s75 offen offset:1024 sc1
    buffer_load_dwordx4 v[164:167], v4, s[48:51], s75 offen offset:2048 sc1
    buffer_load_dwordx4 v[168:171], v4, s[48:51], s75 offen offset:3072 sc1
    s_add_u32 s75, s75, 4096
    buffer_load_dwordx4 v[172:175], v4, s[48:51], s75 offen offset:0 sc1
    buffer_load_dwordx4 v[176:179], v4, s[48:51], s75 offen offset:1024 sc1
    buffer_load_dwordx4 v[180:183], v4, s[48:51], s75 offen offset:2048 sc1
    buffer_load_dwordx4 v[184:187], v4, s[48:51], s75 offen offset:3072 sc1
    s_add_u32 s75, s75, 4096
    buffer_load_dwordx4 v[188:191], v4, s[48:51], s75 offen offset:0 sc1
    buffer_load_dwordx4 v[192:195], v4, s[48:51], s75 offen offset:1024 sc1
    buffer_load_dwordx4 v[196:199], v4, s[48:51], s75 offen offset:2048 sc1
    buffer_load_dwordx4 v[200:203], v4, s[48:51], s75 offen offset:3072 sc1
    s_add_u32 s75, s75, 4096
    buffer_load_dwordx4 v[204:207], v4, s[48:51], s75 offen offset:0 sc1
    buffer_load_dwordx4 v[208:211], v4, s[48:51], s75 offen offset:1024 sc1
    buffer_load_dwordx4 v[212:215], v4, s[48:51], s75 offen offset:2048 sc1
    buffer_load_dwordx4 v[216:219], v4, s[48:51], s75 offen offset:3072 sc1
    s_add_u32 s75, s75, 4096
    buffer_load_dwordx4 v[220:223], v4, s[48:51], s75 offen offset:0 sc1
    buffer_load_dwordx4 v[224:227], v4, s[48:51], s75 offen offset:1024 sc1
    buffer_load_dwordx4 v[228:231], v4, s[48:51], s75 offen offset:2048 sc1
    buffer_load_dwordx4 v[232:235], v4, s[48:51], s75 offen offset:3072 sc1
    s_add_u32 s75, s75, 4096
    buffer_load_dwordx4 v[236:239], v4, s[48:51], s75 offen offset:0 sc1
    buffer_load_dwordx4 v[240:243], v4, s[48:51], s75 offen offset:1024 sc1
    buffer_load_dwordx4 v[244:247], v4, s[48:51], s75 offen offset:2048 sc1
    buffer_load_dwordx4 v[248:251], v4, s[48:51], s75 offen offset:3072 sc1
    s_add_u32 s75, s75, 4096
    buffer_load_dwordx4 v[252:255], v4, s[48:51], s75 offen offset:0 sc1
    s_sub_u32 s71, s32, s9
    s_mul_i32 s71, s71, 12288
    s_add_u32 s70, s70, s71
    s_mov_b32 s74, 20000
    s_mov_b32 s69, 1098907648
L_b_accA:
    s_mov_b32 exec_lo, 16777215
    s_mov_b32 exec_hi, 16777215
    buffer_load_dword v16, v8, s[48:51], s70 offen offset:0 sc1
    buffer_load_dword v17, v8, s[48:51], s70 offen offset:192 sc1
    buffer_load_dword v18, v8, s[48:51], s70 offen offset:384 sc1
    buffer_load_dword v19, v8, s[48:51], s70 offen offset:576 sc1
    buffer_load_dword v20, v8, s[48:51], s70 offen offset:768 sc1
    buffer_load_dword v21, v8, s[48:51], s70 offen offset:960 sc1
    buffer_load_dword v22, v8, s[48:51], s70 offen offset:1152 sc1
    buffer_load_dword v23, v8, s[48:51], s70 offen offset:1344 sc1
    buffer_load_dword v24, v8, s[48:51], s70 offen offset:1536 sc1
    buffer_load_dword v25, v8, s[48:51], s70 offen offset:1728 sc1
    buffer_load_dword v26, v8, s[48:51], s70 offen offset:1920 sc1
    buffer_load_dword v27, v8, s[48:51], s70 offen offset:2112 sc1
    s_mov_b64 exec, -1
    s_waitcnt vmcnt(9)
    v_min3_f32 v88, v16, v17, v18
    s_waitcnt vmcnt(7)
    v_min3_f32 v88, v88, v19, v20
    s_waitcnt vmcnt(5)
    v_min3_f32 v88, v88, v21, v22
    s_waitcnt vmcnt(4)
    v_min_f32 v88, v88, v23
    s_waitcnt vmcnt(1)
    v_min3_f32 v89, v24, v25, v26
    s_waitcnt vmcnt(0)
    v_min_f32 v89, v89, v27
    v_cmp_neq_f32 vcc, s69, v88
    v_cmp_neq_f32 s[36:37], s69, v89
    s_nop 0
    s_or_b32 s36, s36, vcc_lo
    s_or_b32 s36, s36, vcc_hi
    s_and_b32 s36, s36, 14680064
    s_cbranch_scc1 L_b_retryA
L_b_doneA:
    buffer_load_dword v10, v13, s[48:51], 0 offen sc1
    v_cvt_pk_bf16_f32 v88, v16, v17
    v_cvt_pk_bf16_f32 v89, v18, v19
    v_cvt_pk_bf16_f32 v90, v20, v21
    v_cvt_pk_bf16_f32 v91, v22, v23
    v_cvt_pk_bf16_f32 v92, v24, v25
    v_cvt_pk_bf16_f32 v93, v26, v27
    s_mov_b64 exec, s[26:27]
    ds_write_b64 v6, v[88:89]
    ds_write_b64 v6, v[90:91] offset:16
    s_mov_b64 exec, 0x1fffff
    ds_write_b64 v6, v[92:93] offset:32
    s_mov_b64 exec, -1
    s_waitcnt lgkmcnt(0)
    s_barrier
    ds_read_b64 v[48:49], v3 offset:0
    ds_read_b64 v[50:51], v3 offset:8
    ds_read_b64 v[52:53], v3 offset:16
    ds_read_b64 v[54:55], v3 offset:24
    ds_read_b64 v[56:57], v3 offset:32
    ds_read_b64 v[62:63], v3 offset:1680
    ds_read_b64 v[64:65], v3 offset:1688
    ds_read_b64 v[66:67], v3 offset:1696
    ds_read_b64 v[68:69], v3 offset:1704
    ds_read_b64 v[70:71], v3 offset:1712
    s_waitcnt lgkmcnt(8)
    v_mfma_f32_32x32x16_bf16 v[16:31], v[48:51], v[128:131], 0
    s_waitcnt lgkmcnt(6)
    v_mfma_f32_32x32x16_bf16 v[16:31], v[52:55], v[132:135], v[16:31]
    s_waitcnt lgkmcnt(5)
    v_mfma_f32_32x32x16_bf16 v[16:31], v[56:59], v[136:139], v[16:31]
    s_waitcnt lgkmcnt(4)
    v_mfma_f32_32x32x16_bf16 v[32:47], v[60:63], v[136:139], 0
    s_waitcnt lgkmcnt(2)
    v_mfma_f32_32x32x16_bf16 v[32:47], v[64:67], v[140:143], v[32:47]
    s_waitcnt lgkmcnt(0)
    v_mfma_f32_32x32x16_bf16 v[32:47], v[68:71], v[144:147], v[32:47]
    s_nop 5
    v_add_f32 v26, 897988541, v26
    v_rcp_f32 v26, v26
    s_nop 0
    v_pk_mul_f32 v[16:17], v[16:17], v[26:27] op_sel_hi:[1,0]
    v_pk_mul_f32 v[18:19], v[18:19], v[26:27] op_sel_hi:[1,0]
    v_pk_mul_f32 v[20:21], v[20:21], v[26:27] op_sel_hi:[1,0]
    v_pk_mul_f32 v[22:23], v[22:23], v[26:27] op_sel_hi:[1,0]
    v_pk_mul_f32 v[24:25], v[24:25], v[26:27] op_sel_hi:[1,0]
    v_cvt_pk_bf16_f32 v96, v16, v17
    v_cvt_pk_bf16_f32 v97, v18, v19
    v_cvt_pk_bf16_f32 v98, v20, v21
    v_cvt_pk_bf16_f32 v99, v22, v23
    v_cvt_pk_bf16_f32 v100, v24, v25
    v_add_f32 v42, 897988541, v42
    v_rcp_f32 v42, v42
    s_nop 0
    v_pk_mul_f32 v[32:33], v[32:33], v[42:43] op_sel_hi:[1,0]
    v_pk_mul_f32 v[34:35], v[34:35], v[42:43] op_sel_hi:[1,0]
    v_pk_mul_f32 v[36:37], v[36:37], v[42:43] op_sel_hi:[1,0]
    v_pk_mul_f32 v[38:39], v[38:39], v[42:43] op_sel_hi:[1,0]
    v_pk_mul_f32 v[40:41], v[40:41], v[42:43] op_sel_hi:[1,0]
    v_cvt_pk_bf16_f32 v101, v32, v33
    v_cvt_pk_bf16_f32 v102, v34, v35
    v_cvt_pk_bf16_f32 v103, v36, v37
    v_cvt_pk_bf16_f32 v104, v38, v39
    v_cvt_pk_bf16_f32 v105, v40, v41
    buffer_store_dwordx4 v[96:99], v5, s[48:51], s72 offen sc1
    buffer_store_dwordx4 v[100:103], v5, s[48:51], s72 offen offset:256 sc1
    buffer_store_dwordx2 v[104:105], v9, s[48:51], s72 offen offset:1024 sc1
    s_waitcnt vmcnt(3)
    v_cmp_ne_u32 vcc, s79, v10
    s_mov_b32 s68, 20000
L_flg10:
    s_nop 1
    s_cmp_eq_u64 vcc, 0
    s_cbranch_scc1 L_flg10_done
    s_sleep 4
    buffer_load_dword v10, v13, s[48:51], 0 offen sc1
    s_waitcnt vmcnt(0)
    v_cmp_ne_u32 vcc, s79, v10
    s_sub_u32 s68, s68, 1
    s_cmp_lg_u32 s68, 0
    s_cbranch_scc1 L_flg10
L_flg10_done:
    s_lshl_b32 s68, s8, 1
    s_and_b32 s69, s9, 1
    s_add_u32 s68, s68, s69
    s_mul_i32 s68, s68, 81920
    s_mul_i32 s69, s3, 5120
    s_add_u32 s68, s68, s69
    s_add_u32 s76, s68, 1572864
    s_add_u32 s68, s3, 1
    s_and_b32 s68, s68, 3
    s_mul_i32 s16, s68, 15360
    s_mul_i32 s68, s68, 20480
    s_add_u32 s70, s68, s76
    s_add_u32 s68, s3, 2
    s_and_b32 s68, s68, 3
    s_mul_i32 s17, s68, 15360
    s_mul_i32 s68, s68, 20480
    s_add_u32 s71, s68, s76
    s_add_u32 s68, s3, 3
    s_and_b32 s68, s68, 3
    s_mul_i32 s18, s68, 15360
    s_mul_i32 s68, s68, 20480
    s_add_u32 s72, s68, s76
    s_add_u32 s68, s3, 4
    s_and_b32 s68, s68, 3
    s_mul_i32 s19, s68, 15360
    s_mul_i32 s68, s68, 20480
    s_add_u32 s73, s68, s76
    v_add_u32 v5, 4096, v4
    v_add_u32 v6, s16, v4
    v_add_u32 v7, s17, v4
    v_add_u32 v8, s18, v4
    v_add_u32 v9, s19, v4
    s_mov_b32 s74, 20000
    s_barrier
L_b_retryB:
    v_and_b32 v10, 3, v2
    v_mul_u32_u24 v10, 20480, v10
    v_bfe_u32 v11, v2, 2, 2
    v_mul_u32_u24 v11, 1280, v11
    v_add_u32 v10, v10, v11
    s_waitcnt vmcnt(0) lgkmcnt(0)
L_b_canB:
    s_sub_u32 s74, s74, 1
    s_cmp_le_i32 s74, 0
    s_cbranch_scc1 L_b_contB3
    buffer_load_dword v11, v10, s[48:51], s76 offen offset:1276 sc1
    s_waitcnt vmcnt(0)
    v_cmp_eq_u32 vcc, -1, v11
    s_nop 0
    s_cmp_eq_u64 vcc, 0
    s_cbranch_scc1 L_b_bulkB
    s_sleep 4
    s_branch L_b_canB
L_b_bulkB:
    buffer_load_dwordx4 v[116:119], v4, s[48:51], s70 offen offset:0 sc1
    buffer_load_dwordx4 v[120:123], v4, s[48:51], s70 offen offset:1024 sc1
    buffer_load_dwordx4 v[124:127], v4, s[48:51], s70 offen offset:2048 sc1
    buffer_load_dwordx4 v[128:131], v4, s[48:51], s70 offen offset:3072 sc1
    buffer_load_dwordx4 v[132:135], v5, s[48:51], s70 offen sc1
    buffer_load_dwordx4 v[96:99], v4, s[48:51], s71 offen offset:0 sc1
    buffer_load_dwordx4 v[100:103], v4, s[48:51], s71 offen offset:1024 sc1
    buffer_load_dwordx4 v[104:107], v4, s[48:51], s71 offen offset:2048 sc1
    buffer_load_dwordx4 v[108:111], v4, s[48:51], s71 offen offset:3072 sc1
    buffer_load_dwordx4 v[112:115], v5, s[48:51], s71 offen sc1
    buffer_load_dwordx4 v[76:79], v4, s[48:51], s72 offen offset:0 sc1
    buffer_load_dwordx4 v[80:83], v4, s[48:51], s72 offen offset:1024 sc1
    buffer_load_dwordx4 v[84:87], v4, s[48:51], s72 offen offset:2048 sc1
    buffer_load_dwordx4 v[88:91], v4, s[48:51], s72 offen offset:3072 sc1
    buffer_load_dwordx4 v[92:95], v5, s[48:51], s72 offen sc1
    buffer_load_dwordx4 v[16:19], v4, s[48:51], s73 offen offset:0 sc1
    buffer_load_dwordx4 v[20:23], v4, s[48:51], s73 offen offset:1024 sc1
    buffer_load_dwordx4 v[24:27], v4, s[48:51], s73 offen offset:2048 sc1
    buffer_load_dwordx4 v[28:31], v4, s[48:51], s73 offen offset:3072 sc1
    buffer_load_dwordx4 v[32:35], v5, s[48:51], s73 offen sc1
    s_waitcnt vmcnt(17)
    v_max3_u32 v10, v116, v120, v124
    s_waitcnt vmcnt(15)
    v_max3_u32 v10, v10, v128, v132
    v_max3_u32 v11, v119, v123, v127
    v_max3_u32 v11, v11, v131, v135
    v_max_u32 v10, v10, v11
    v_cmp_eq_u32 vcc, -1, v10
    s_nop 0
    s_cmp_lg_u64 vcc, 0
    s_cbranch_scc1 L_b_retryB
L_b_contB0:
    v_mfma_f32_16x16x32_bf16 v[36:39], v[156:159], v[116:119], 0
    v_mfma_f32_16x16x32_bf16 v[40:43], v[160:163], v[116:119], 0
    v_mfma_f32_16x16x32_bf16 v[44:47], v[164:167], v[116:119], 0
    v_mfma_f32_16x16x32_bf16 v[48:51], v[168:171], v[116:119], 0
    v_mfma_f32_16x16x32_bf16 v[52:55], v[172:175], v[116:119], 0
    v_mfma_f32_16x16x32_bf16 v[36:39], v[176:179], v[120:123], v[36:39]
    v_mfma_f32_16x16x32_bf16 v[40:43], v[180:183], v[120:123], v[40:43]
    v_mfma_f32_16x16x32_bf16 v[44:47], v[184:187], v[120:123], v[44:47]
    v_mfma_f32_16x16x32_bf16 v[48:51], v[188:191], v[120:123], v[48:51]
    v_mfma_f32_16x16x32_bf16 v[52:55], v[192:195], v[120:123], v[52:55]
    v_mfma_f32_16x16x32_bf16 v[36:39], v[196:199], v[124:127], v[36:39]
    v_mfma_f32_16x16x32_bf16 v[40:43], v[200:203], v[124:127], v[40:43]
    v_mfma_f32_16x16x32_bf16 v[44:47], v[204:207], v[124:127], v[44:47]
    v_mfma_f32_16x16x32_bf16 v[48:51], v[208:211], v[124:127], v[48:51]
    v_mfma_f32_16x16x32_bf16 v[52:55], v[212:215], v[124:127], v[52:55]
    v_mfma_f32_16x16x32_bf16 v[36:39], v[216:219], v[128:131], v[36:39]
    v_mfma_f32_16x16x32_bf16 v[40:43], v[220:223], v[128:131], v[40:43]
    v_mfma_f32_16x16x32_bf16 v[44:47], v[224:227], v[128:131], v[44:47]
    v_mfma_f32_16x16x32_bf16 v[48:51], v[228:231], v[128:131], v[48:51]
    v_mfma_f32_16x16x32_bf16 v[52:55], v[232:235], v[128:131], v[52:55]
    v_mfma_f32_16x16x32_bf16 v[36:39], v[236:239], v[132:135], v[36:39]
    v_mfma_f32_16x16x32_bf16 v[40:43], v[240:243], v[132:135], v[40:43]
    v_mfma_f32_16x16x32_bf16 v[44:47], v[244:247], v[132:135], v[44:47]
    v_mfma_f32_16x16x32_bf16 v[48:51], v[248:251], v[132:135], v[48:51]
    v_mfma_f32_16x16x32_bf16 v[52:55], v[252:255], v[132:135], v[52:55]
    s_waitcnt vmcnt(12)
    v_max3_u32 v10, v96, v100, v104
    s_waitcnt vmcnt(10)
    v_max3_u32 v10, v10, v108, v112
    v_max3_u32 v11, v99, v103, v107
    v_max3_u32 v11, v11, v111, v115
    v_max_u32 v10, v10, v11
    v_cmp_eq_u32 vcc, -1, v10
    s_nop 0
    s_cmp_lg_u64 vcc, 0
    s_cbranch_scc1 L_b_retryB
L_b_contB1:
    v_mfma_f32_16x16x32_bf16 v[56:59], v[156:159], v[96:99], 0
    v_mfma_f32_16x16x32_bf16 v[60:63], v[160:163], v[96:99], 0
    v_mfma_f32_16x16x32_bf16 v[64:67], v[164:167], v[96:99], 0
    v_mfma_f32_16x16x32_bf16 v[68:71], v[168:171], v[96:99], 0
    v_mfma_f32_16x16x32_bf16 v[72:75], v[172:175], v[96:99], 0
    v_mfma_f32_16x16x32_bf16 v[56:59], v[176:179], v[100:103], v[56:59]
    v_mfma_f32_16x16x32_bf16 v[60:63], v[180:183], v[100:103], v[60:63]
    v_mfma_f32_16x16x32_bf16 v[64:67], v[184:187], v[100:103], v[64:67]
    v_mfma_f32_16x16x32_bf16 v[68:71], v[188:191], v[100:103], v[68:71]
    v_mfma_f32_16x16x32_bf16 v[72:75], v[192:195], v[100:103], v[72:75]
    v_mfma_f32_16x16x32_bf16 v[56:59], v[196:199], v[104:107], v[56:59]
    ds_write_b128 v6, v[36:39] offset:10240
    v_mfma_f32_16x16x32_bf16 v[60:63], v[200:203], v[104:107], v[60:63]
    v_mfma_f32_16x16x32_bf16 v[64:67], v[204:207], v[104:107], v[64:67]
    v_mfma_f32_16x16x32_bf16 v[68:71], v[208:211], v[104:107], v[68:71]
    ds_write_b128 v6, v[40:43] offset:11264
    v_mfma_f32_16x16x32_bf16 v[72:75], v[212:215], v[104:107], v[72:75]
    v_mfma_f32_16x16x32_bf16 v[56:59], v[216:219], v[108:111], v[56:59]
    v_mfma_f32_16x16x32_bf16 v[60:63], v[220:223], v[108:111], v[60:63]
    ds_write_b128 v6, v[44:47] offset:12288
    v_mfma_f32_16x16x32_bf16 v[64:67], v[224:227], v[108:111], v[64:67]
    v_mfma_f32_16x16x32_bf16 v[68:71], v[228:231], v[108:111], v[68:71]
    v_mfma_f32_16x16x32_bf16 v[72:75], v[232:235], v[108:111], v[72:75]
    ds_write_b128 v6, v[48:51] offset:13312
    v_mfma_f32_16x16x32_bf16 v[56:59], v[236:239], v[112:115], v[56:59]
    v_mfma_f32_16x16x32_bf16 v[60:63], v[240:243], v[112:115], v[60:63]
    v_mfma_f32_16x16x32_bf16 v[64:67], v[244:247], v[112:115], v[64:67]
    ds_write_b128 v6, v[52:55] offset:14336
    v_mfma_f32_16x16x32_bf16 v[68:71], v[248:251], v[112:115], v[68:71]
    v_mfma_f32_16x16x32_bf16 v[72:75], v[252:255], v[112:115], v[72:75]
    s_waitcnt vmcnt(7)
    v_max3_u32 v10, v76, v80, v84
    s_waitcnt vmcnt(5)
    v_max3_u32 v10, v10, v88, v92
    v_max3_u32 v11, v79, v83, v87
    v_max3_u32 v11, v11, v91, v95
    v_max_u32 v10, v10, v11
    v_cmp_eq_u32 vcc, -1, v10
    s_nop 0
    s_cmp_lg_u64 vcc, 0
    s_cbranch_scc1 L_b_retryB
L_b_contB2:
    v_mfma_f32_16x16x32_bf16 v[116:119], v[156:159], v[76:79], 0
    v_mfma_f32_16x16x32_bf16 v[120:123], v[160:163], v[76:79], 0
    v_mfma_f32_16x16x32_bf16 v[124:127], v[164:167], v[76:79], 0
    v_mfma_f32_16x16x32_bf16 v[128:131], v[168:171], v[76:79], 0
    v_mfma_f32_16x16x32_bf16 v[132:135], v[172:175], v[76:79], 0
    v_mfma_f32_16x16x32_bf16 v[116:119], v[176:179], v[80:83], v[116:119]
    v_mfma_f32_16x16x32_bf16 v[120:123], v[180:183], v[80:83], v[120:123]
    v_mfma_f32_16x16x32_bf16 v[124:127], v[184:187], v[80:83], v[124:127]
    v_mfma_f32_16x16x32_bf16 v[128:131], v[188:191], v[80:83], v[128:131]
    v_mfma_f32_16x16x32_bf16 v[132:135], v[192:195], v[80:83], v[132:135]
    v_mfma_f32_16x16x32_bf16 v[116:119], v[196:199], v[84:87], v[116:119]
    ds_write_b128 v7, v[56:59] offset:5120
    v_mfma_f32_16x16x32_bf16 v[120:123], v[200:203], v[84:87], v[120:123]
    v_mfma_f32_16x16x32_bf16 v[124:127], v[204:207], v[84:87], v[124:127]
    v_mfma_f32_16x16x32_bf16 v[128:131], v[208:211], v[84:87], v[128:131]
    ds_write_b128 v7, v[60:63] offset:6144
    v_mfma_f32_16x16x32_bf16 v[132:135], v[212:215], v[84:87], v[132:135]
    v_mfma_f32_16x16x32_bf16 v[116:119], v[216:219], v[88:91], v[116:119]
    v_mfma_f32_16x16x32_bf16 v[120:123], v[220:223], v[88:91], v[120:123]
    ds_write_b128 v7, v[64:67] offset:7168
    v_mfma_f32_16x16x32_bf16 v[124:127], v[224:227], v[88:91], v[124:127]
    v_mfma_f32_16x16x32_bf16 v[128:131], v[228:231], v[88:91], v[128:131]
    v_mfma_f32_16x16x32_bf16 v[132:135], v[232:235], v[88:91], v[132:135]
    ds_write_b128 v7, v[68:71] offset:8192
    v_mfma_f32_16x16x32_bf16 v[116:119], v[236:239], v[92:95], v[116:119]
    v_mfma_f32_16x16x32_bf16 v[120:123], v[240:243], v[92:95], v[120:123]
    v_mfma_f32_16x16x32_bf16 v[124:127], v[244:247], v[92:95], v[124:127]
    ds_write_b128 v7, v[72:75] offset:9216
    v_mfma_f32_16x16x32_bf16 v[128:131], v[248:251], v[92:95], v[128:131]
    v_mfma_f32_16x16x32_bf16 v[132:135], v[252:255], v[92:95], v[132:135]
    s_waitcnt vmcnt(2)
    v_max3_u32 v10, v16, v20, v24
    s_waitcnt vmcnt(0)
    v_max3_u32 v10, v10, v28, v32
    v_max3_u32 v11, v19, v23, v27
    v_max3_u32 v11, v11, v31, v35
    v_max_u32 v10, v10, v11
    v_cmp_eq_u32 vcc, -1, v10
    s_nop 0
    s_cmp_lg_u64 vcc, 0
    s_cbranch_scc1 L_b_retryB
L_b_contB3:
    v_mfma_f32_16x16x32_bf16 v[96:99], v[156:159], v[16:19], 0
    v_mfma_f32_16x16x32_bf16 v[100:103], v[160:163], v[16:19], 0
    v_mfma_f32_16x16x32_bf16 v[104:107], v[164:167], v[16:19], 0
    v_mfma_f32_16x16x32_bf16 v[108:111], v[168:171], v[16:19], 0
    v_mfma_f32_16x16x32_bf16 v[112:115], v[172:175], v[16:19], 0
    v_mfma_f32_16x16x32_bf16 v[96:99], v[176:179], v[20:23], v[96:99]
    v_mfma_f32_16x16x32_bf16 v[100:103], v[180:183], v[20:23], v[100:103]
    v_mfma_f32_16x16x32_bf16 v[104:107], v[184:187], v[20:23], v[104:107]
    v_mfma_f32_16x16x32_bf16 v[108:111], v[188:191], v[20:23], v[108:111]
    v_mfma_f32_16x16x32_bf16 v[112:115], v[192:195], v[20:23], v[112:115]
    v_mfma_f32_16x16x32_bf16 v[96:99], v[196:199], v[24:27], v[96:99]
    ds_write_b128 v8, v[116:119] offset:0
    v_mfma_f32_16x16x32_bf16 v[100:103], v[200:203], v[24:27], v[100:103]
    v_mfma_f32_16x16x32_bf16 v[104:107], v[204:207], v[24:27], v[104:107]
    v_mfma_f32_16x16x32_bf16 v[108:111], v[208:211], v[24:27], v[108:111]
    ds_write_b128 v8, v[120:123] offset:1024
    v_mfma_f32_16x16x32_bf16 v[112:115], v[212:215], v[24:27], v[112:115]
    v_mfma_f32_16x16x32_bf16 v[96:99], v[216:219], v[28:31], v[96:99]
    v_mfma_f32_16x16x32_bf16 v[100:103], v[220:223], v[28:31], v[100:103]
    ds_write_b128 v8, v[124:127] offset:2048
    v_mfma_f32_16x16x32_bf16 v[104:107], v[224:227], v[28:31], v[104:107]
    v_mfma_f32_16x16x32_bf16 v[108:111], v[228:231], v[28:31], v[108:111]
    v_mfma_f32_16x16x32_bf16 v[112:115], v[232:235], v[28:31], v[112:115]
    ds_write_b128 v8, v[128:131] offset:3072
    v_mfma_f32_16x16x32_bf16 v[96:99], v[236:239], v[32:35], v[96:99]
    v_mfma_f32_16x16x32_bf16 v[100:103], v[240:243], v[32:35], v[100:103]
    v_mfma_f32_16x16x32_bf16 v[104:107], v[244:247], v[32:35], v[104:107]
    ds_write_b128 v8, v[132:135] offset:4096
    v_mfma_f32_16x16x32_bf16 v[108:111], v[248:251], v[32:35], v[108:111]
    v_mfma_f32_16x16x32_bf16 v[112:115], v[252:255], v[32:35], v[112:115]
    s_mov_b32 s64, s42
    s_and_b32 s65, s43, 0xffff
    s_mov_b32 s66, 5242880
    s_mov_b32 s67, 0x20000
    v_and_b32 v12, 15, v2
    v_mul_u32_u24 v12, 2560, v12
    v_lshrrev_b32 v13, 4, v2
    v_lshl_add_u32 v14, v13, 3, v12
    v_lshl_add_u32 v12, v13, 4, v12
    s_lshl_b32 s68, s8, 1
    s_and_b32 s69, s9, 1
    s_add_u32 s68, s68, s69
    s_lshl_b32 s68, s68, 2
    s_add_u32 s68, s68, s3
    s_mul_i32 s68, s68, 40960
    s_lshr_b32 s69, s9, 1
    s_mul_i32 s69, s69, 160
    s_add_u32 s68, s68, s69
    s_add_u32 s68, s68, 1280
    v_add_f32 v10, v36, v56
    v_add_f32 v11, v116, v96
    v_cmp_u_f32 vcc, v10, v11
    s_nop 0
    s_cmp_lg_u64 vcc, 0
    s_cbranch_scc1 L_b_retryB2
L_b_doneB:
    s_waitcnt lgkmcnt(0)
    s_barrier
    ds_read_b128 v[156:159], v9 offset:0
    ds_read_b128 v[160:163], v9 offset:5120
    ds_read_b128 v[164:167], v9 offset:10240
    ds_read_b128 v[168:171], v9 offset:1024
    ds_read_b128 v[172:175], v9 offset:6144
    ds_read_b128 v[176:179], v9 offset:11264
    ds_read_b128 v[180:183], v9 offset:2048
    ds_read_b128 v[184:187], v9 offset:7168
    ds_read_b128 v[188:191], v9 offset:12288
    ds_read_b128 v[192:195], v9 offset:3072
    ds_read_b128 v[196:199], v9 offset:8192
    ds_read_b128 v[200:203], v9 offset:13312
    ds_read_b128 v[204:207], v9 offset:4096
    ds_read_b128 v[208:211], v9 offset:9216
    ds_read_b128 v[212:215], v9 offset:14336
    s_waitcnt lgkmcnt(14)
    v_pk_add_f32 v[96:97], v[96:97], v[156:157]
    s_waitcnt lgkmcnt(12)
    v_pk_add_f32 v[160:161], v[160:161], v[164:165]
    v_pk_add_f32 v[96:97], v[96:97], v[160:161]
    v_pk_add_f32 v[98:99], v[98:99], v[158:159]
    v_pk_add_f32 v[162:163], v[162:163], v[166:167]
    v_pk_add_f32 v[98:99], v[98:99], v[162:163]
    v_cvt_pk_bf16_f32 v16, v96, v97
    v_cvt_pk_bf16_f32 v17, v98, v99
    s_waitcnt lgkmcnt(11)
    v_pk_add_f32 v[100:101], v[100:101], v[168:169]
    s_waitcnt lgkmcnt(9)
    v_pk_add_f32 v[172:173], v[172:173], v[176:177]
    v_pk_add_f32 v[100:101], v[100:101], v[172:173]
    v_pk_add_f32 v[102:103], v[102:103], v[170:171]
    v_pk_add_f32 v[174:175], v[174:175], v[178:179]
    v_pk_add_f32 v[102:103], v[102:103], v[174:175]
    v_cvt_pk_bf16_f32 v18, v100, v101
    v_cvt_pk_bf16_f32 v19, v102, v103
    buffer_store_dwordx4 v[16:19], v12, s[64:67], s68 offen
    s_waitcnt lgkmcnt(8)
    v_pk_add_f32 v[104:105], v[104:105], v[180:181]
    s_waitcnt lgkmcnt(6)
    v_pk_add_f32 v[184:185], v[184:185], v[188:189]
    v_pk_add_f32 v[104:105], v[104:105], v[184:185]
    v_pk_add_f32 v[106:107], v[106:107], v[182:183]
    v_pk_add_f32 v[186:187], v[186:187], v[190:191]
    v_pk_add_f32 v[106:107], v[106:107], v[186:187]
    v_cvt_pk_bf16_f32 v20, v104, v105
    v_cvt_pk_bf16_f32 v21, v106, v107
    s_waitcnt lgkmcnt(5)
    v_pk_add_f32 v[108:109], v[108:109], v[192:193]
    s_waitcnt lgkmcnt(3)
    v_pk_add_f32 v[196:197], v[196:197], v[200:201]
    v_pk_add_f32 v[108:109], v[108:109], v[196:197]
    v_pk_add_f32 v[110:111], v[110:111], v[194:195]
    v_pk_add_f32 v[198:199], v[198:199], v[202:203]
    v_pk_add_f32 v[110:111], v[110:111], v[198:199]
    v_cvt_pk_bf16_f32 v22, v108, v109
    v_cvt_pk_bf16_f32 v23, v110, v111
    buffer_store_dwordx4 v[20:23], v12, s[64:67], s68 offen offset:64
    s_waitcnt lgkmcnt(2)
    v_pk_add_f32 v[112:113], v[112:113], v[204:205]
    s_waitcnt lgkmcnt(0)
    v_pk_add_f32 v[208:209], v[208:209], v[212:213]
    v_pk_add_f32 v[112:113], v[112:113], v[208:209]
    v_pk_add_f32 v[114:115], v[114:115], v[206:207]
    v_pk_add_f32 v[210:211], v[210:211], v[214:215]
    v_pk_add_f32 v[114:115], v[114:115], v[210:211]
    v_cvt_pk_bf16_f32 v24, v112, v113
    v_cvt_pk_bf16_f32 v25, v114, v115
    buffer_store_dwordx2 v[24:25], v14, s[64:67], s68 offen offset:128
    s_add_u32 s68, s2, s3
    s_cmp_lg_u32 s68, 0
    s_cbranch_scc1 L_end
    s_mov_b64 exec, 1
    buffer_store_dword v15, v15, s[52:55], 0 offen sc1
    s_endpgm
L_b_retryA:
    s_sub_u32 s74, s74, 1
    s_cmp_le_i32 s74, 0
    s_cbranch_scc1 L_b_doneA
    s_sleep 8
    s_mov_b64 exec, 0x200000
    buffer_load_dword v88, v8, s[48:51], s70 offen offset:2112 sc1
    s_waitcnt vmcnt(0)
    v_cmp_neq_f32 vcc, s69, v88
    s_mov_b64 exec, -1
    s_cmp_lg_u64 vcc, 0
    s_cbranch_scc1 L_b_retryA
    s_branch L_b_accA
L_b_retryB2:
    s_cmp_le_i32 s74, 0
    s_cbranch_scc1 L_b_doneB
    s_branch L_b_retryB
L_end:
    s_endpgm
L_code_end:
.section .rodata,"a"
.p2align 6
.amdhsa_kernel concat_heads__ssm_conv_s4__linear_kernel_hedgehog__prompt_kernel
  .amdhsa_next_free_vgpr 256
  .amdhsa_next_free_sgpr 102
  .amdhsa_accum_offset 256
  .amdhsa_group_segment_fixed_size 0
  .amdhsa_kernarg_size 128
  .amdhsa_user_sgpr_count 2
  .amdhsa_user_sgpr_kernarg_segment_ptr 1
  .amdhsa_system_sgpr_workgroup_id_x 1
.end_amdhsa_kernel
```
